```python
import torch

def _softmax(x, axis=-1):
    return torch.softmax(x, dim=axis)
def _gelu(x):
    return torch.nn.functional.gelu(x, approximate="tanh")
def _silu(x):
    return torch.nn.functional.silu(x)
def _sigmoid(x):
    return torch.sigmoid(x)
def _layernorm(x, axis=-1, eps=1e-5):
    m = x.mean(dim=axis, keepdim=True)
    v = x.var(dim=axis, keepdim=True, unbiased=False)
    return (x - m) / torch.sqrt(v + eps)
def _scatter_add(tgt, idx, src, axis=0):
    return tgt.clone().index_add_(axis, idx, src)
def _segment_sum(src, seg, n):
    out = torch.zeros((n,) + src.shape[1:], dtype=src.dtype)
    return out.index_add_(0, seg, src)
def _pad(x, pw):
    flat = tuple(v for pair in reversed(pw) for v in pair)
    return torch.nn.functional.pad(x, flat)

kernel_name = 'standalone__edge_featured_mpnn_gatedgcn__graph'

def setup_inputs():

    _w = (lambda a: (lambda t: t.to(torch.bfloat16) if t.is_floating_point() else t)(torch.as_tensor(a)))
    N, deg, D, De = 12500, 64, 64, max(0, 1)
    E = N * deg
    return {
        "x": _w((lambda *s: torch.randn(*s, dtype=torch.bfloat16) * 0.8)(N, D)),
        "e_attr": _w((lambda *s: torch.randn(*s, dtype=torch.bfloat16) * 0.8)(E, De)),
        "src": _w((lambda lo, hi, *s: torch.randint(lo, hi, s))(0, N, E).to(torch.int64)),
        "dst": _w((lambda lo, hi, *s: torch.randint(lo, hi, s))(0, N, E).to(torch.int64)),
        "w_a": _w((lambda *s: torch.randn(*s, dtype=torch.bfloat16) * 0.8)(D, D)),
        "w_b": _w((lambda *s: torch.randn(*s, dtype=torch.bfloat16) * 0.8)(D, D)),
        "w_c": _w((lambda *s: torch.randn(*s, dtype=torch.bfloat16) * 0.8)(De, D)),
        "w_u": _w((lambda *s: torch.randn(*s, dtype=torch.bfloat16) * 0.05)(D, D)),
        "w_v": _w((lambda *s: torch.randn(*s, dtype=torch.bfloat16) * 0.05)(D, D)),
    }

def reference(x, e_attr, src, dst, w_a, w_b, w_c, w_u, w_v):
    N, D = x.shape
    hv = x @ w_v
    g = x[dst] @ w_a + x[src] @ w_b + e_attr @ w_c
    eta = _sigmoid(g)
    denom = _segment_sum(eta, dst, N) + 1e-6
    eta_n = eta / denom[dst]
    agg = _segment_sum(eta_n * hv[src], dst, N)
    z = x @ w_u + agg
    relu_z = torch.where(z > 0, z, 0 * z)
    return x + relu_z
```

```asm
; @launch grid=(256,1,1) block=(1024,1,1) lds=163840
.amdgcn_target "amdgcn-amd-amdhsa--gfx950"
.text
.globl standalone__edge_featured_mpnn_gatedgcn__graph_kernel
.p2align 8
.type standalone__edge_featured_mpnn_gatedgcn__graph_kernel,@function
standalone__edge_featured_mpnn_gatedgcn__graph_kernel:
    s_cmp_ge_u32 s2, 256
    s_cbranch_scc1 L_end
    s_load_dwordx16 s[4:19], s[0:1], 0
    s_load_dwordx8 s[20:27], s[0:1], 64
    v_lshrrev_b32 v1, 6, v0
    v_lshlrev_b32 v3, 4, v0
    v_readfirstlane_b32 s3, v1
    v_and_b32 v116, 63, v0
    v_and_b32 v1, 15, v0
    s_and_b32 s40, s2, 7
    s_lshl_b32 s40, s40, 5
    s_lshr_b32 s59, s2, 3
    s_add_u32 s61, s59, s40
    s_mul_i32 s60, s61, 49
    s_cmp_ge_u32 s3, 8
    s_cbranch_scc1 L_noedge
    s_mul_i32 s40, s2, 12512
    v_add_u32 v12, s40, v3
    v_add_u32 v13, 8192, v12
    v_lshrrev_b32 v14, 1, v12
    v_lshrrev_b32 v15, 1, v13
    s_mul_i32 s41, s2, 782
    s_sub_u32 s41, 199488, s41
    s_min_u32 s41, s41, 270
    v_cmp_gt_u32 s[50:51], s41, v0
    s_or_b32 s40, s2, s3
    s_cbranch_scc1 L_nn
    s_memrealtime s[42:43]
    v_mov_b32 v18, 0
    s_waitcnt lgkmcnt(0)
    s_lshl_b64 s[42:43], s[42:43], 25
    s_or_b32 s42, s42, 1
    v_mov_b32 v16, s42
    v_mov_b32 v17, s43
    s_mov_b64 exec, 1
    global_store_dwordx2 v18, v[16:17], s[24:25] sc1
    s_mov_b64 exec, -1
L_nn:
    s_waitcnt lgkmcnt(0)
    global_load_dwordx4 v[20:23], v12, s[10:11]
    s_mov_b64 exec, s[50:51]
    s_cbranch_execz L_e1
    global_load_dwordx4 v[40:43], v13, s[10:11]
L_e1:
    s_cmp_eq_u32 s3, 4
    s_cbranch_scc1 L_e3
    s_barrier
L_e3:
    s_cbranch_execz L_e2
    global_load_dwordx4 v[44:47], v13, s[8:9]
    global_load_dwordx2 v[48:49], v15, s[6:7]
L_e2:
    s_mov_b64 exec, -1
    s_cbranch_scc0 L_e4
    s_barrier
L_e4:
    global_load_dwordx4 v[24:27], v12, s[8:9]
    global_load_dwordx2 v[28:29], v14, s[6:7]
    s_setprio 3
    s_branch L_common
L_noedge:
    v_mov_b32 v56, 0
    v_mov_b32 v57, 0
    v_mov_b32 v58, 0
    v_mov_b32 v59, 0
    s_cmp_lg_u32 s3, 9
    s_cbranch_scc1 L_n1
    v_lshlrev_b32 v16, 4, v116
    v_lshlrev_b32 v17, 2, v116
    ds_write_b128 v16, v[56:59] offset:0
    ds_write_b32 v17, v56 offset:1536
L_n1:
    s_cmp_lg_u32 s3, 8
    s_cbranch_scc1 L_n2
    s_getpc_b64 s[42:43]
L_pc:
    s_sub_u32 s42, s42, L_pc-standalone__edge_featured_mpnn_gatedgcn__graph_kernel
    s_subb_u32 s43, s43, 0
    s_lshl_b32 s41, s59, 9
    v_lshlrev_b32 v10, 7, v116
    v_add_u32 v11, s41, v10
    s_lshl_b32 s41, s59, 8
    v_add_u32 v10, s41, v10
    s_mov_b64 exec, 15
    global_load_dword v60, v11, s[42:43]
    s_mov_b64 exec, 3
    s_waitcnt lgkmcnt(0)
    global_load_dword v61, v10, s[14:15]
    global_load_dword v62, v10, s[20:21]
    global_load_dword v63, v10, s[12:13]
    global_load_dword v64, v10, s[18:19]
    s_mov_b64 exec, -1
L_n2:
    s_lshl_b32 s40, s60, 7
    s_sub_u32 s40, s40, 8192
    v_add_u32 v14, s40, v3
    v_add_u32 v15, 4096, v14
    v_min_u32 v14, 1599984, v14
    v_min_u32 v15, 1599984, v15
    v_lshlrev_b32 v11, 3, v1
    s_waitcnt lgkmcnt(0)
    global_load_dwordx2 v[4:5], v11, s[16:17]
    s_barrier
    s_cmp_ge_u32 s3, 12
    s_cbranch_scc1 L_common
    global_load_dwordx4 v[88:91], v14, s[4:5]
    global_load_dwordx4 v[92:95], v15, s[4:5]
L_common:
    v_mov_b32 v119, 4
    s_lshl_b32 s40, s3, 4
    v_add_u32 v16, s40, v1
    v_lshrrev_b32 v17, 4, v16
    v_and_b32 v113, 15, v16
    v_lshlrev_b32 v113, 3, v113
    v_lshl_add_u32 v113, v17, 7, v113
    v_add_u32 v113, 12582912, v113
    s_and_b32 s41, s2, 7
    s_lshl_b32 s41, s41, 16
    v_add_u32 v113, s41, v113
    v_lshrrev_b32 v17, 2, v116
    v_add_u32 v17, s40, v17
    s_lshl_b32 s41, s61, 3
    s_add_u32 s41, s41, 4194304
    v_lshlrev_b32 v115, 11, v17
    v_add_u32 v115, s41, v115
    v_mul_u32_u24 v114, 12544, v17
    v_lshlrev_b32 v1, 4, v1
    v_and_b32 v17, 3, v116
    v_and_b32 v117, 60, v116
    v_lshl_add_u32 v117, v17, 7, v117
    v_min_u32 v16, 49, v116
    v_mul_u32_u24 v118, 512, v16
    v_lshl_add_u32 v118, v116, 4, v118
    v_add_u32 v118, 134912, v118
    v_mov_b32 v112, 1552
    v_mov_b32 v126, 0x4b400000
    s_mov_b32 s64, 0x7e000000
    s_mov_b32 s65, 2
    s_mov_b64 s[62:63], 0
    s_mov_b32 s30, 268435456
    s_mov_b32 s31, 0x20000
    s_mov_b32 s34, 3215360
    s_mov_b32 s35, 0x20000
    s_mov_b32 s38, 1600000
    s_mov_b32 s39, 0x20000
    s_mov_b32 s28, s26
    s_mov_b32 s29, s27
    s_add_u32 s32, s26, 8388608
    s_addc_u32 s33, s27, 0
    s_mov_b32 s36, s22
    s_mov_b32 s37, s23
    s_cmp_ge_u32 s3, 8
    s_cbranch_scc1 L_gw
    s_mov_b32 s44, -49
    s_mov_b32 s45, 117440512
    s_mov_b32 s46, 0x78000000
    s_mov_b32 s47, 0xffff0000
    s_mov_b64 s[52:53], 0
    v_mov_b32 v19, 1588
    v_lshlrev_b32 v18, 4, v116
    v_lshlrev_b32 v14, 3, v116
    v_add_u32 v12, 150272, v18
    v_add_u32 v13, 150272, v14
    v_add_u32 v11, 151296, v3
    s_cmp_eq_u64 s[50:51], 0
    s_cbranch_scc1 L_a1
    s_waitcnt vmcnt(4)
    s_mov_b64 exec, s[50:51]
    v_mul_u32_u24 v50, 21400, v40
    v_lshrrev_b32 v50, 20, v50
    v_lshlrev_b32 v54, 2, v50
    ds_add_rtn_u32 v68, v54, v119 offset:0
    v_mul_u32_u24 v51, 21400, v41
    v_lshrrev_b32 v51, 20, v51
    v_lshlrev_b32 v55, 2, v51
    ds_add_rtn_u32 v69, v55, v119 offset:0
    v_mul_u32_u24 v52, 21400, v42
    v_lshrrev_b32 v52, 20, v52
    v_lshlrev_b32 v56, 2, v52
    ds_add_rtn_u32 v70, v56, v119 offset:0
    v_mul_u32_u24 v53, 21400, v43
    v_lshrrev_b32 v53, 20, v53
    v_lshlrev_b32 v57, 2, v53
    ds_add_rtn_u32 v71, v57, v119 offset:0
    v_mad_i32_i24 v40, v50, s44, v40
    v_mad_i32_i24 v41, v51, s44, v41
    v_mad_i32_i24 v42, v52, s44, v42
    v_mad_i32_i24 v43, v53, s44, v43
    v_add_u32 v54, 150272, v54
    v_add_u32 v55, 150272, v55
    v_add_u32 v56, 150272, v56
    v_add_u32 v57, 150272, v57
    s_mov_b64 exec, -1
    s_branch L_a2
L_a1:
    s_waitcnt vmcnt(2)
L_a2:
    v_mul_u32_u24 v30, 21400, v20
    v_lshrrev_b32 v30, 20, v30
    v_lshlrev_b32 v34, 2, v30
    ds_add_rtn_u32 v64, v34, v119 offset:0
    v_mul_u32_u24 v31, 21400, v21
    v_lshrrev_b32 v31, 20, v31
    v_lshlrev_b32 v35, 2, v31
    ds_add_rtn_u32 v65, v35, v119 offset:0
    v_mul_u32_u24 v32, 21400, v22
    v_lshrrev_b32 v32, 20, v32
    v_lshlrev_b32 v36, 2, v32
    ds_add_rtn_u32 v66, v36, v119 offset:0
    v_mul_u32_u24 v33, 21400, v23
    v_lshrrev_b32 v33, 20, v33
    v_lshlrev_b32 v37, 2, v33
    ds_add_rtn_u32 v67, v37, v119 offset:0
    v_mad_i32_i24 v20, v30, s44, v20
    v_mad_i32_i24 v21, v31, s44, v21
    v_mad_i32_i24 v22, v32, s44, v22
    v_mad_i32_i24 v23, v33, s44, v23
    v_add_u32 v34, 150272, v34
    v_add_u32 v35, 150272, v35
    v_add_u32 v36, 150272, v36
    v_add_u32 v37, 150272, v37
    s_mov_b64 exec, 1
    s_waitcnt lgkmcnt(0)
    ds_add_u32 v19, v119
L_eb1:
    ds_read_b32 v15, v19
    s_waitcnt lgkmcnt(0)
    v_cmp_gt_u32 vcc, 32, v15
    s_cbranch_vccnz L_eb1
    s_mov_b64 exec, -1
    ds_read_b128 v[80:83], v18 offset:0
    ds_read_b64 v[96:97], v14 offset:0
    ds_read_b64 v[98:99], v14 offset:512
    s_waitcnt lgkmcnt(2)
    v_add_u32 v81, v80, v81
    v_add_u32 v82, v81, v82
    v_add_u32 v83, v82, v83
    s_nop 1
    v_add_u32_dpp v88, v83, v83 row_shr:1 row_mask:0xf bank_mask:0xf bound_ctrl:0
    s_nop 1
    v_add_u32_dpp v88, v88, v88 row_shr:2 row_mask:0xf bank_mask:0xf bound_ctrl:0
    s_nop 1
    v_add_u32_dpp v88, v88, v88 row_shr:4 row_mask:0xf bank_mask:0xf bound_ctrl:0
    s_nop 1
    v_add_u32_dpp v88, v88, v88 row_shr:8 row_mask:0xf bank_mask:0xf bound_ctrl:0
    s_nop 1
    v_add_u32_dpp v88, v88, v88 row_bcast:15 row_mask:0xa bank_mask:0xf
    s_nop 1
    v_add_u32_dpp v88, v88, v88 row_bcast:31 row_mask:0xc bank_mask:0xf
    v_sub_u32 v84, v88, v83
    v_add_u32 v84, 151296, v84
    v_add_u32 v85, v84, v80
    v_add_u32 v86, v84, v81
    v_add_u32 v87, v84, v82
    ds_write_b128 v12, v[84:87]
    ds_read_b32 v72, v34
    ds_read_b32 v73, v35
    ds_read_b32 v74, v36
    ds_read_b32 v75, v37
    ds_read_b64 v[100:101], v13
    ds_read_b64 v[102:103], v13 offset:512
    s_cmp_eq_u64 s[50:51], 0
    s_cbranch_scc1 L_b1
    s_mov_b64 exec, s[50:51]
    ds_read_b32 v76, v54
    ds_read_b32 v77, v55
    ds_read_b32 v78, v56
    ds_read_b32 v79, v57
    s_waitcnt vmcnt(2)
    v_lshlrev_b32 v50, 16, v48
    v_lshlrev_b32 v52, 16, v49
    v_mul_f32 v50, s45, v50
    v_mul_f32 v51, s45, v48
    v_mul_f32 v52, s45, v52
    v_mul_f32 v53, s45, v49
    v_add_lshl_u32 v44, v44, 1, 2
    v_bfi_b32 v44, 3, v40, v44
    v_lshlrev_b32 v40, 25, v40
    v_bfi_b32 v40, s46, v40, v50
    v_bfi_b32 v44, s47, v40, v44
    v_add_lshl_u32 v45, v45, 1, 2
    v_bfi_b32 v45, 3, v41, v45
    v_lshlrev_b32 v41, 25, v41
    v_bfi_b32 v41, s46, v41, v51
    v_bfi_b32 v45, s47, v41, v45
    v_add_lshl_u32 v46, v46, 1, 2
    v_bfi_b32 v46, 3, v42, v46
    v_lshlrev_b32 v42, 25, v42
    v_bfi_b32 v42, s46, v42, v52
    v_bfi_b32 v46, s47, v42, v46
    v_add_lshl_u32 v47, v47, 1, 2
    v_bfi_b32 v47, 3, v43, v47
    v_lshlrev_b32 v43, 25, v43
    v_bfi_b32 v43, s46, v43, v53
    v_bfi_b32 v47, s47, v43, v47
    v_or3_b32 v50, v50, v51, v52
    v_or_b32 v50, v50, v53
    v_and_b32 v50, s46, v50
    v_cmp_ne_u32 vcc, 0, v50
    s_or_b64 s[52:53], s[52:53], vcc
    s_waitcnt lgkmcnt(0)
    v_add_u32 v68, v68, v76
    v_add_u32 v69, v69, v77
    v_add_u32 v70, v70, v78
    v_add_u32 v71, v71, v79
    ds_write_b32 v68, v44
    ds_write_b32 v69, v45
    ds_write_b32 v70, v46
    ds_write_b32 v71, v47
    s_mov_b64 exec, -1
L_b1:
    s_waitcnt vmcnt(0)
    v_lshlrev_b32 v30, 16, v28
    v_lshlrev_b32 v32, 16, v29
    v_mul_f32 v30, s45, v30
    v_mul_f32 v31, s45, v28
    v_mul_f32 v32, s45, v32
    v_mul_f32 v33, s45, v29
    v_add_lshl_u32 v24, v24, 1, 2
    v_bfi_b32 v24, 3, v20, v24
    v_lshlrev_b32 v20, 25, v20
    v_bfi_b32 v20, s46, v20, v30
    v_bfi_b32 v24, s47, v20, v24
    v_add_lshl_u32 v25, v25, 1, 2
    v_bfi_b32 v25, 3, v21, v25
    v_lshlrev_b32 v21, 25, v21
    v_bfi_b32 v21, s46, v21, v31
    v_bfi_b32 v25, s47, v21, v25
    v_add_lshl_u32 v26, v26, 1, 2
    v_bfi_b32 v26, 3, v22, v26
    v_lshlrev_b32 v22, 25, v22
    v_bfi_b32 v22, s46, v22, v32
    v_bfi_b32 v26, s47, v22, v26
    v_add_lshl_u32 v27, v27, 1, 2
    v_bfi_b32 v27, 3, v23, v27
    v_lshlrev_b32 v23, 25, v23
    v_bfi_b32 v23, s46, v23, v33
    v_bfi_b32 v27, s47, v23, v27
    v_or3_b32 v30, v30, v31, v32
    v_or_b32 v30, v30, v33
    v_and_b32 v30, s46, v30
    v_cmp_ne_u32 vcc, 0, v30
    s_or_b64 s[52:53], s[52:53], vcc
    s_waitcnt lgkmcnt(0)
    v_add_u32 v64, v64, v72
    v_add_u32 v65, v65, v73
    v_add_u32 v66, v66, v74
    v_add_u32 v67, v67, v75
    ds_write_b32 v64, v24
    ds_write_b32 v65, v25
    ds_write_b32 v66, v26
    ds_write_b32 v67, v27
L_b2:
    s_cmp_lg_u64 s[52:53], 0
    s_cbranch_scc1 L_ebad
L_ebad_back:
    s_mul_i32 s54, s2, 12544
    s_add_u32 s55, s54, 8192
    s_mov_b64 exec, 1
    s_waitcnt lgkmcnt(0)
    ds_add_u32 v19, v119
L_eb2:
    ds_read_b32 v15, v19
    s_waitcnt lgkmcnt(0)
    v_cmp_gt_u32 vcc, 64, v15
    s_cbranch_vccnz L_eb2
    s_mov_b64 exec, -1
    ds_read_b128 v[20:23], v11
    ds_read_b128 v[24:27], v11 offset:8192
    s_waitcnt lgkmcnt(1)
    buffer_store_dwordx4 v[20:23], v3, s[28:31], s54 offen sc1
    s_mov_b64 exec, s[50:51]
    s_cbranch_execz L_c1
    s_waitcnt lgkmcnt(0)
    buffer_store_dwordx4 v[24:27], v3, s[28:31], s55 offen sc1
L_c1:
    s_mov_b64 exec, -1
    v_subrev_u32 v100, 151296, v100
    v_lshrrev_b32 v100, 2, v100
    v_lshl_or_b32 v104, v96, 10, v100
    v_subrev_u32 v101, 151296, v101
    v_lshrrev_b32 v101, 2, v101
    v_lshl_or_b32 v106, v97, 10, v101
    v_subrev_u32 v102, 151296, v102
    v_lshrrev_b32 v102, 2, v102
    v_lshl_or_b32 v108, v98, 10, v102
    v_subrev_u32 v103, 151296, v103
    v_lshrrev_b32 v103, 2, v103
    v_lshl_or_b32 v110, v99, 10, v103
    v_mov_b32 v16, 1536
    s_lshl_b32 s54, s2, 11
    s_add_u32 s54, s54, 4194304
L_sg:
    ds_read_b64 v[92:93], v16 offset:40
    s_waitcnt lgkmcnt(0)
    v_cmp_eq_u32 vcc, 0, v92
    s_cbranch_vccnz L_sg
    v_and_b32 v92, -2, v92
    s_mov_b64 exec, 1
    s_waitcnt vmcnt(0)
    ds_add_rtn_u32 v17, v16, v119 offset:32
    s_mov_b64 exec, -1
    ds_read_b32 v20, v16
    s_waitcnt lgkmcnt(0)
    v_readfirstlane_b32 s42, v17
    v_cmp_gt_u32 vcc, 32, v20
    v_lshl_or_b32 v20, v20, 20, v92
    s_cmp_lg_u32 s42, 28
    s_cbranch_scc1 L_nosig
    v_or_b32 v104, v104, v20
    v_mov_b32 v105, v93
    v_or_b32 v106, v106, v20
    v_mov_b32 v107, v93
    v_or_b32 v108, v108, v20
    v_mov_b32 v109, v93
    v_or_b32 v110, v110, v20
    v_mov_b32 v111, v93
    s_cbranch_vccz L_nosig
    buffer_store_dwordx4 v[104:107], v18, s[28:31], s54 offen sc1
    buffer_store_dwordx4 v[108:111], v18, s[28:31], s54 offen offset:1024 sc1
L_nosig:
    s_barrier
    v_mov_b32 v56, 0
    v_mov_b32 v57, 0
    v_mov_b32 v58, 0
    v_mov_b32 v59, 0
    v_add_u32 v16, 109312, v3
    ds_write_b128 v16, v[56:59] offset:0
    ds_write_b128 v16, v[56:59] offset:8192
    ds_write_b128 v16, v[56:59] offset:16384
    s_cmp_lg_u32 s3, 0
    s_cbranch_scc1 L_z1
    ds_write_b128 v16, v[56:59] offset:24576
L_z1:
    s_sleep 11
    global_load_dwordx2 v[94:95], v115, s[26:27] sc1
    s_branch L_prep
L_gw:
    s_cmp_lg_u32 s3, 9
    s_cbranch_scc1 L_g2
    ds_write_b32 v117, v118 offset:1024
    v_mov_b32 v57, -1
    v_lshlrev_b32 v18, 3, v116
    ds_write_b64 v18, v[56:57] offset:1792
L_g2:
    s_cmp_ge_u32 s3, 12
    s_cbranch_scc1 L_t1
    s_waitcnt vmcnt(2)
    s_branch L_t2
L_t1:
    s_waitcnt vmcnt(0)
L_t2:
    s_mov_b32 s44, 0xbfb8aa3b
    v_and_b32 v7, 0xffff0000, v5
    v_lshlrev_b32 v6, 16, v5
    v_and_b32 v5, 0xffff0000, v4
    v_lshlrev_b32 v4, 16, v4
    v_mul_f32 v4, s44, v4
    v_mul_f32 v5, s44, v5
    v_mul_f32 v6, s44, v6
    v_mul_f32 v7, s44, v7
    v_bfe_u32 v8, v0, 4, 5
    v_cvt_f32_u32 v9, v8
    v_mul_f32 v96, 0x3d800000, v9
    v_add_f32 v97, 2.0, v96
    v_add_f32 v98, -4.0, v96
    v_add_f32 v99, -2.0, v96
    v_mul_f32 v100, 0x3a000000, v9
    v_add_f32 v101, 0x3c800000, v100
    v_add_f32 v102, 0x3d000000, v100
    v_add_f32 v103, 0x3d400000, v100
    v_mov_b32 v17, 0xc1300000
    v_lshl_add_u32 v9, v8, 8, v1
    v_lshl_add_u32 v8, v8, 9, v1
    v_add_u32 v8, 43776, v8
    v_fma_f32 v20, v4, v96, v17
    v_fma_f32 v21, v5, v96, v17
    v_fma_f32 v22, v6, v96, v17
    v_fma_f32 v23, v7, v96, v17
    v_fma_f32 v24, v4, v97, v17
    v_fma_f32 v25, v5, v97, v17
    v_fma_f32 v26, v6, v97, v17
    v_fma_f32 v27, v7, v97, v17
    v_fma_f32 v28, v4, v98, v17
    v_fma_f32 v29, v5, v98, v17
    v_fma_f32 v30, v6, v98, v17
    v_fma_f32 v31, v7, v98, v17
    v_fma_f32 v32, v4, v99, v17
    v_fma_f32 v33, v5, v99, v17
    v_fma_f32 v34, v6, v99, v17
    v_fma_f32 v35, v7, v99, v17
    v_mul_f32 v36, v4, v100
    v_mul_f32 v37, v5, v100
    v_mul_f32 v38, v6, v100
    v_mul_f32 v39, v7, v100
    v_mul_f32 v40, v4, v101
    v_mul_f32 v41, v5, v101
    v_mul_f32 v42, v6, v101
    v_mul_f32 v43, v7, v101
    v_mul_f32 v44, v4, v102
    v_mul_f32 v45, v5, v102
    v_mul_f32 v46, v6, v102
    v_mul_f32 v47, v7, v102
    v_mul_f32 v48, v4, v103
    v_mul_f32 v49, v5, v103
    v_mul_f32 v50, v6, v103
    v_mul_f32 v51, v7, v103
    v_exp_f32 v20, v20
    v_exp_f32 v21, v21
    v_exp_f32 v22, v22
    v_exp_f32 v23, v23
    v_exp_f32 v24, v24
    v_exp_f32 v25, v25
    v_exp_f32 v26, v26
    v_exp_f32 v27, v27
    v_exp_f32 v28, v28
    v_exp_f32 v29, v29
    v_exp_f32 v30, v30
    v_exp_f32 v31, v31
    v_exp_f32 v32, v32
    v_exp_f32 v33, v33
    v_exp_f32 v34, v34
    v_exp_f32 v35, v35
    v_exp_f32 v36, v36
    v_exp_f32 v37, v37
    v_exp_f32 v38, v38
    v_exp_f32 v39, v39
    v_exp_f32 v40, v40
    v_exp_f32 v41, v41
    v_exp_f32 v42, v42
    v_exp_f32 v43, v43
    v_exp_f32 v44, v44
    v_exp_f32 v45, v45
    v_exp_f32 v46, v46
    v_exp_f32 v47, v47
    v_exp_f32 v48, v48
    v_exp_f32 v49, v49
    v_exp_f32 v50, v50
    v_exp_f32 v51, v51
    v_max3_f32 v16, |v4|, |v5|, |v6|
    ds_write_b128 v9, v[20:23] offset:11008
    ds_write_b128 v9, v[24:27] offset:19200
    ds_write_b128 v9, v[28:31] offset:27392
    ds_write_b128 v9, v[32:35] offset:35584
    ds_write_b128 v8, v[36:39] offset:0
    ds_write_b128 v8, v[40:43] offset:16384
    ds_write_b128 v8, v[44:47] offset:32768
    ds_write_b128 v8, v[48:51] offset:49152
    v_max_f32_e64 v16, v16, |v7|
    v_cmp_nge_f32 vcc, 4.0, v16
    s_cbranch_vccnz L_wbad
L_wbad_back:
    v_and_b32 v2, 255, v0
    v_lshlrev_b32 v3, 4, v2
    v_lshrrev_b32 v12, 3, v2
    v_and_b32 v13, 7, v2
    v_mov_b32 v46, 0
    s_cmp_ge_u32 s3, 12
    s_cselect_b64 s[40:41], s[12:13], s[14:15]
    s_cselect_b64 s[42:43], s[18:19], s[20:21]
    s_cselect_b32 s55, 20480, 0
    s_cselect_b32 s57, 36, 0
    s_add_u32 s55, s55, 109312
    s_add_u32 s57, s57, 1548
    v_add_u32 v15, 4096, v3
    v_mov_b32 v50, 1
    s_setprio 1
    s_cmp_lg_u32 s3, 15
    s_cbranch_scc1 L_g4
    global_load_dwordx2 v[50:51], v46, s[24:25] sc1
L_g4:
    global_load_dwordx4 v[72:75], v3, s[40:41]
    global_load_dwordx4 v[76:79], v15, s[40:41]
    global_load_dwordx4 v[80:83], v3, s[42:43]
    global_load_dwordx4 v[84:87], v15, s[42:43]
    v_mul_u32_u24 v16, 160, v12
    v_lshl_add_u32 v16, v13, 2, v16
    v_add_u32 v16, s55, v16
    v_mul_u32_u24 v17, 136, v12
    v_lshl_add_u32 v17, v13, 4, v17
    v_add_u32 v17, 2304, v17
    v_add_u32 v18, 4352, v17
    v_mov_b32 v19, s2
    v_lshrrev_b32 v15, 4, v19
    v_and_b32 v127, 15, v19
    v_lshlrev_b32 v127, 3, v127
    v_lshl_add_u32 v127, v15, 7, v127
    v_add_u32 v127, 12582912, v127
    v_lshl_add_u32 v127, v116, 16, v127
    s_mov_b32 s48, 0x05040100
    s_mov_b32 s49, 0x07060302
    s_and_b32 s54, s3, 3
    v_bfe_u32 v12, v0, 2, 4
    v_and_b32 v13, 3, v0
    v_mul_u32_u24 v12, 160, v12
    v_lshl_add_u32 v12, v13, 3, v12
    v_add_u32 v12, s55, v12
    v_and_b32 v13, 15, v0
    v_bfe_u32 v14, v0, 4, 2
    v_mul_u32_u24 v13, 136, v13
    v_lshl_add_u32 v13, v14, 3, v13
    s_mul_i32 s56, s54, 2176
    s_add_u32 s56, s56, 2304
    v_add_u32 v13, s56, v13
    s_lshl_b32 s56, s54, 2
    v_add_u32 v14, s56, v14
    v_mov_b32 v19, s57
    v_mov_b32 v47, 1548
    s_mov_b32 s43, 0
    s_waitcnt vmcnt(4)
    s_cmp_lt_u32 s3, 12
    s_cbranch_scc1 L_g7
    s_cmp_lg_u32 s3, 15
    s_cbranch_scc1 L_g6
    ds_write_b64 v46, v[50:51] offset:1576
    s_branch L_g6
L_g7:
    ds_write2_b64 v17, v[88:89], v[90:91] offset0:0 offset1:1
    ds_write2_b64 v18, v[92:93], v[94:95] offset0:0 offset1:1
L_g6:
    s_waitcnt vmcnt(3)
    v_perm_b32 v40, v74, v72, s48
    v_perm_b32 v41, v74, v72, s49
    v_perm_b32 v42, v75, v73, s48
    v_perm_b32 v43, v75, v73, s49
    ds_write2_b32 v16, v40, v41 offset0:0 offset1:8
    ds_write2_b32 v16, v42, v43 offset0:16 offset1:24
    v_add_u32 v16, 5120, v16
    s_waitcnt vmcnt(2)
    v_perm_b32 v40, v78, v76, s48
    v_perm_b32 v41, v78, v76, s49
    v_perm_b32 v42, v79, v77, s48
    v_perm_b32 v43, v79, v77, s49
    ds_write2_b32 v16, v40, v41 offset0:0 offset1:8
    ds_write2_b32 v16, v42, v43 offset0:16 offset1:24
    v_add_u32 v16, 5120, v16
    s_waitcnt vmcnt(1)
    v_perm_b32 v40, v82, v80, s48
    v_perm_b32 v41, v82, v80, s49
    v_perm_b32 v42, v83, v81, s48
    v_perm_b32 v43, v83, v81, s49
    ds_write2_b32 v16, v40, v41 offset0:0 offset1:8
    ds_write2_b32 v16, v42, v43 offset0:16 offset1:24
    v_add_u32 v16, 5120, v16
    s_waitcnt vmcnt(0)
    v_perm_b32 v40, v86, v84, s48
    v_perm_b32 v41, v86, v84, s49
    v_perm_b32 v42, v87, v85, s48
    v_perm_b32 v43, v87, v85, s49
    ds_write2_b32 v16, v40, v41 offset0:0 offset1:8
    ds_write2_b32 v16, v42, v43 offset0:16 offset1:24
L_gop:
    s_waitcnt vmcnt(0)
    v_cmp_eq_u32 vcc, 0, v50
    s_cbranch_vccnz L_gowait
L_goback:
    s_mov_b64 exec, 1
    s_cmp_lg_u32 s3, 15
    s_cbranch_scc1 L_g5
    v_or_b32 v50, 1, v50
    s_waitcnt lgkmcnt(0)
    ds_write_b64 v46, v[50:51] offset:1576
L_g5:
    s_waitcnt lgkmcnt(0)
    ds_add_u32 v19, v119
L_sb:
    ds_read_b32 v15, v19
    s_waitcnt lgkmcnt(0)
    v_cmp_gt_u32 vcc, 16, v15
    s_cbranch_vccnz L_sb
    s_cmp_ge_u32 s3, 12
    s_cbranch_scc1 L_au
    s_mov_b64 exec, -1
    s_setprio 2
    ds_read2_b64 v[84:87], v13 offset0:0 offset1:4
    ds_read2_b64 v[88:91], v13 offset0:8 offset1:12
    ds_read_b64_tr_b16 v[20:21], v12 offset:0
    ds_read_b64_tr_b16 v[22:23], v12 offset:2560
    ds_read_b64_tr_b16 v[24:25], v12 offset:5120
    ds_read_b64_tr_b16 v[26:27], v12 offset:7680
    ds_read_b64_tr_b16 v[28:29], v12 offset:32
    ds_read_b64_tr_b16 v[30:31], v12 offset:2592
    ds_read_b64_tr_b16 v[32:33], v12 offset:5152
    ds_read_b64_tr_b16 v[34:35], v12 offset:7712
    ds_read_b64_tr_b16 v[36:37], v12 offset:64
    ds_read_b64_tr_b16 v[38:39], v12 offset:2624
    ds_read_b64_tr_b16 v[40:41], v12 offset:5184
    ds_read_b64_tr_b16 v[42:43], v12 offset:7744
    s_waitcnt lgkmcnt(8)
    v_mfma_f32_16x16x32_bf16 v[96:99], v[84:87], v[20:23], 0
    v_mfma_f32_16x16x32_bf16 v[96:99], v[88:91], v[24:27], v[96:99]
    ds_read_b64_tr_b16 v[44:45], v12 offset:96
    ds_read_b64_tr_b16 v[46:47], v12 offset:2656
    ds_read_b64_tr_b16 v[48:49], v12 offset:5216
    ds_read_b64_tr_b16 v[50:51], v12 offset:7776
    s_waitcnt lgkmcnt(8)
    v_mfma_f32_16x16x32_bf16 v[100:103], v[84:87], v[28:31], 0
    v_mfma_f32_16x16x32_bf16 v[100:103], v[88:91], v[32:35], v[100:103]
    ds_read_b64_tr_b16 v[52:53], v12 offset:10240
    ds_read_b64_tr_b16 v[54:55], v12 offset:12800
    ds_read_b64_tr_b16 v[56:57], v12 offset:15360
    ds_read_b64_tr_b16 v[58:59], v12 offset:17920
    s_waitcnt lgkmcnt(8)
    v_mfma_f32_16x16x32_bf16 v[104:107], v[84:87], v[36:39], 0
    v_mfma_f32_16x16x32_bf16 v[104:107], v[88:91], v[40:43], v[104:107]
    ds_read_b64_tr_b16 v[60:61], v12 offset:10272
    ds_read_b64_tr_b16 v[62:63], v12 offset:12832
    ds_read_b64_tr_b16 v[64:65], v12 offset:15392
    ds_read_b64_tr_b16 v[66:67], v12 offset:17952
    s_waitcnt lgkmcnt(8)
    v_mfma_f32_16x16x32_bf16 v[108:111], v[84:87], v[44:47], 0
    v_mfma_f32_16x16x32_bf16 v[108:111], v[88:91], v[48:51], v[108:111]
    ds_read_b64_tr_b16 v[68:69], v12 offset:10304
    ds_read_b64_tr_b16 v[70:71], v12 offset:12864
    ds_read_b64_tr_b16 v[72:73], v12 offset:15424
    ds_read_b64_tr_b16 v[74:75], v12 offset:17984
    s_waitcnt lgkmcnt(8)
    v_mfma_f32_16x16x32_bf16 v[20:23], v[84:87], v[52:55], 0
    v_mfma_f32_16x16x32_bf16 v[20:23], v[88:91], v[56:59], v[20:23]
    ds_read_b64_tr_b16 v[76:77], v12 offset:10336
    ds_read_b64_tr_b16 v[78:79], v12 offset:12896
    ds_read_b64_tr_b16 v[80:81], v12 offset:15456
    ds_read_b64_tr_b16 v[82:83], v12 offset:18016
    s_waitcnt lgkmcnt(8)
    v_mfma_f32_16x16x32_bf16 v[24:27], v[84:87], v[60:63], 0
    v_mfma_f32_16x16x32_bf16 v[24:27], v[88:91], v[64:67], v[24:27]
    s_waitcnt lgkmcnt(4)
    v_mfma_f32_16x16x32_bf16 v[28:31], v[84:87], v[68:71], 0
    v_mfma_f32_16x16x32_bf16 v[28:31], v[88:91], v[72:75], v[28:31]
    s_waitcnt lgkmcnt(0)
    v_mfma_f32_16x16x32_bf16 v[32:35], v[84:87], v[76:79], 0
    v_mfma_f32_16x16x32_bf16 v[32:35], v[88:91], v[80:83], v[32:35]
    s_mov_b32 s44, 0xbfb8aa3b
    s_mov_b32 s45, 0x42800000
    s_mov_b32 s46, 0x07060100
    s_lshl_b32 s47, s60, 8
    s_add_u32 s47, s47, 8388864
    v_lshl_add_u32 v14, v14, 10, v1
    v_mul_f32 v96, s44, v96
    v_mul_f32 v97, s44, v97
    v_mul_f32 v98, s44, v98
    v_mul_f32 v99, s44, v99
    v_mul_f32 v100, s44, v100
    v_mul_f32 v101, s44, v101
    v_mul_f32 v102, s44, v102
    v_mul_f32 v103, s44, v103
    v_mul_f32 v104, s44, v104
    v_mul_f32 v105, s44, v105
    v_mul_f32 v106, s44, v106
    v_mul_f32 v107, s44, v107
    v_mul_f32 v108, s44, v108
    v_mul_f32 v109, s44, v109
    v_mul_f32 v110, s44, v110
    v_mul_f32 v111, s44, v111
    s_cmp_eq_u32 s54, 3
    s_cselect_b32 exec_lo, 0xffff, -1
    s_cselect_b32 exec_hi, 0, -1
    v_exp_f32 v64, v96
    v_exp_f32 v65, v100
    v_exp_f32 v66, v104
    v_exp_f32 v67, v108
    v_fma_mixlo_f16 v36, v20, s45, 0
    v_fma_mixlo_f16 v37, v24, s45, 0
    v_fma_mixlo_f16 v38, v28, s45, 0
    v_fma_mixlo_f16 v39, v32, s45, 0
    v_add_u32 v64, 0x8000, v64
    v_add_u32 v65, 0x8000, v65
    v_add_u32 v66, 0x8000, v66
    v_add_u32 v67, 0x8000, v67
    v_sub_u32_sdwa v64, v64, v36 clamp dst_sel:DWORD dst_unused:UNUSED_PAD src0_sel:DWORD src1_sel:WORD_0
    v_sub_u32_sdwa v65, v65, v37 clamp dst_sel:DWORD dst_unused:UNUSED_PAD src0_sel:DWORD src1_sel:WORD_0
    v_sub_u32_sdwa v66, v66, v38 clamp dst_sel:DWORD dst_unused:UNUSED_PAD src0_sel:DWORD src1_sel:WORD_0
    v_sub_u32_sdwa v67, v67, v39 clamp dst_sel:DWORD dst_unused:UNUSED_PAD src0_sel:DWORD src1_sel:WORD_0
    v_perm_b32 v64, v64, v36, s46
    v_perm_b32 v65, v65, v37, s46
    v_perm_b32 v66, v66, v38, s46
    v_perm_b32 v67, v67, v39, s46
    buffer_store_dwordx4 v[64:67], v14, s[28:31], s47 offen offset:0 sc1
    s_cbranch_scc1 L_tdone
    v_exp_f32 v68, v97
    v_exp_f32 v69, v101
    v_exp_f32 v70, v105
    v_exp_f32 v71, v109
    v_fma_mixlo_f16 v36, v21, s45, 0
    v_fma_mixlo_f16 v37, v25, s45, 0
    v_fma_mixlo_f16 v38, v29, s45, 0
    v_fma_mixlo_f16 v39, v33, s45, 0
    v_add_u32 v68, 0x8000, v68
    v_add_u32 v69, 0x8000, v69
    v_add_u32 v70, 0x8000, v70
    v_add_u32 v71, 0x8000, v71
    v_sub_u32_sdwa v68, v68, v36 clamp dst_sel:DWORD dst_unused:UNUSED_PAD src0_sel:DWORD src1_sel:WORD_0
    v_sub_u32_sdwa v69, v69, v37 clamp dst_sel:DWORD dst_unused:UNUSED_PAD src0_sel:DWORD src1_sel:WORD_0
    v_sub_u32_sdwa v70, v70, v38 clamp dst_sel:DWORD dst_unused:UNUSED_PAD src0_sel:DWORD src1_sel:WORD_0
    v_sub_u32_sdwa v71, v71, v39 clamp dst_sel:DWORD dst_unused:UNUSED_PAD src0_sel:DWORD src1_sel:WORD_0
    v_perm_b32 v68, v68, v36, s46
    v_perm_b32 v69, v69, v37, s46
    v_perm_b32 v70, v70, v38, s46
    v_perm_b32 v71, v71, v39, s46
    buffer_store_dwordx4 v[68:71], v14, s[28:31], s47 offen offset:256 sc1
    v_exp_f32 v72, v98
    v_exp_f32 v73, v102
    v_exp_f32 v74, v106
    v_exp_f32 v75, v110
    v_fma_mixlo_f16 v36, v22, s45, 0
    v_fma_mixlo_f16 v37, v26, s45, 0
    v_fma_mixlo_f16 v38, v30, s45, 0
    v_fma_mixlo_f16 v39, v34, s45, 0
    v_add_u32 v72, 0x8000, v72
    v_add_u32 v73, 0x8000, v73
    v_add_u32 v74, 0x8000, v74
    v_add_u32 v75, 0x8000, v75
    v_sub_u32_sdwa v72, v72, v36 clamp dst_sel:DWORD dst_unused:UNUSED_PAD src0_sel:DWORD src1_sel:WORD_0
    v_sub_u32_sdwa v73, v73, v37 clamp dst_sel:DWORD dst_unused:UNUSED_PAD src0_sel:DWORD src1_sel:WORD_0
    v_sub_u32_sdwa v74, v74, v38 clamp dst_sel:DWORD dst_unused:UNUSED_PAD src0_sel:DWORD src1_sel:WORD_0
    v_sub_u32_sdwa v75, v75, v39 clamp dst_sel:DWORD dst_unused:UNUSED_PAD src0_sel:DWORD src1_sel:WORD_0
    v_perm_b32 v72, v72, v36, s46
    v_perm_b32 v73, v73, v37, s46
    v_perm_b32 v74, v74, v38, s46
    v_perm_b32 v75, v75, v39, s46
    buffer_store_dwordx4 v[72:75], v14, s[28:31], s47 offen offset:512 sc1
    v_exp_f32 v76, v99
    v_exp_f32 v77, v103
    v_exp_f32 v78, v107
    v_exp_f32 v79, v111
    v_fma_mixlo_f16 v36, v23, s45, 0
    v_fma_mixlo_f16 v37, v27, s45, 0
    v_fma_mixlo_f16 v38, v31, s45, 0
    v_fma_mixlo_f16 v39, v35, s45, 0
    v_add_u32 v76, 0x8000, v76
    v_add_u32 v77, 0x8000, v77
    v_add_u32 v78, 0x8000, v78
    v_add_u32 v79, 0x8000, v79
    v_sub_u32_sdwa v76, v76, v36 clamp dst_sel:DWORD dst_unused:UNUSED_PAD src0_sel:DWORD src1_sel:WORD_0
    v_sub_u32_sdwa v77, v77, v37 clamp dst_sel:DWORD dst_unused:UNUSED_PAD src0_sel:DWORD src1_sel:WORD_0
    v_sub_u32_sdwa v78, v78, v38 clamp dst_sel:DWORD dst_unused:UNUSED_PAD src0_sel:DWORD src1_sel:WORD_0
    v_sub_u32_sdwa v79, v79, v39 clamp dst_sel:DWORD dst_unused:UNUSED_PAD src0_sel:DWORD src1_sel:WORD_0
    v_perm_b32 v76, v76, v36, s46
    v_perm_b32 v77, v77, v37, s46
    v_perm_b32 v78, v78, v38, s46
    v_perm_b32 v79, v79, v39, s46
    buffer_store_dwordx4 v[76:79], v14, s[28:31], s47 offen offset:768 sc1
L_tdone:
    s_mov_b64 exec, -1
    s_setprio 0
    s_or_b32 s56, s2, s54
    s_cmp_lg_u32 s56, 0
    s_cbranch_scc1 L_nodummy
    v_lshlrev_b32 v44, 2, v116
    v_mov_b32 v45, 0x68000000
    s_mov_b32 s56, 8388608
    buffer_store_dword v45, v44, s[28:31], s56 offen sc1
L_nodummy:
    s_barrier
    ds_read_b64 v[92:93], v112 offset:24
    v_max3_f32 v15, v96, v97, v98
    v_max3_f32 v16, |v20|, |v21|, |v22|
    v_max3_f32 v15, v15, v99, v100
    v_max3_f32 v16, v16, |v23|, |v24|
    v_max3_f32 v15, v15, v101, v102
    v_max3_f32 v16, v16, |v25|, |v26|
    v_max3_f32 v15, v15, v103, v104
    v_max3_f32 v16, v16, |v27|, |v28|
    v_max3_f32 v15, v15, v105, v106
    v_max3_f32 v16, v16, |v29|, |v30|
    v_max3_f32 v15, v15, v107, v108
    v_max3_f32 v16, v16, |v31|, |v32|
    v_max3_f32 v15, v15, v109, v110
    v_max3_f32 v16, v16, |v33|, |v34|
    v_max3_f32 v15, v15, v110, v111
    v_max3_f32 v16, v16, |v34|, |v35|
    v_cmp_lt_f32 vcc, 0x42480000, v15
    s_mov_b64 s[42:43], vcc
    v_cmp_lt_f32 vcc, 0x447a0000, v16
    s_or_b64 s[42:43], s[42:43], vcc
    s_cbranch_scc0 L_tok
    v_mov_b32 v16, 1572
    v_mov_b32 v17, 16
    ds_or_b32 v16, v17
L_tok:
    v_mov_b32 v8, 1544
    s_mov_b64 exec, 1
    s_waitcnt vmcnt(0) lgkmcnt(0)
    ds_add_rtn_u32 v9, v8, v119
    s_mov_b64 exec, -1
    v_and_b32 v92, -2, v92
    s_mov_b64 exec, 255
    ds_read_b32 v11, v8 offset:28
    s_waitcnt lgkmcnt(0)
    v_readfirstlane_b32 s42, v9
    v_cmp_gt_u32 vcc, 32, v11
    v_or_b32 v20, v92, v11
    v_mov_b32 v21, v93
    s_cmp_eq_u32 s42, 12
    s_cselect_b64 exec, vcc, 0
    s_cbranch_execz L_nosigt
    global_store_dwordx2 v127, v[20:21], s[26:27] sc1
L_nosigt:
    s_mov_b64 exec, -1
    global_load_dwordx2 v[94:95], v115, s[26:27] sc1
    s_branch L_prep
L_au:
L_sb2:
    ds_read_b32 v15, v47
    s_waitcnt lgkmcnt(0)
    v_cmp_gt_u32 vcc, 16, v15
    s_cbranch_vccnz L_sb2
    s_mov_b64 exec, -1
    ds_read2_b64 v[84:87], v13 offset0:0 offset1:4
    ds_read2_b64 v[88:91], v13 offset0:8 offset1:12
    ds_read_b64_tr_b16 v[20:21], v12 offset:0
    ds_read_b64_tr_b16 v[22:23], v12 offset:2560
    ds_read_b64_tr_b16 v[24:25], v12 offset:5120
    ds_read_b64_tr_b16 v[26:27], v12 offset:7680
    ds_read_b64_tr_b16 v[28:29], v12 offset:32
    ds_read_b64_tr_b16 v[30:31], v12 offset:2592
    ds_read_b64_tr_b16 v[32:33], v12 offset:5152
    ds_read_b64_tr_b16 v[34:35], v12 offset:7712
    ds_read_b64_tr_b16 v[36:37], v12 offset:64
    ds_read_b64_tr_b16 v[38:39], v12 offset:2624
    ds_read_b64_tr_b16 v[40:41], v12 offset:5184
    ds_read_b64_tr_b16 v[42:43], v12 offset:7744
    s_waitcnt lgkmcnt(8)
    v_mfma_f32_16x16x32_bf16 v[96:99], v[84:87], v[20:23], 0
    v_mfma_f32_16x16x32_bf16 v[96:99], v[88:91], v[24:27], v[96:99]
    ds_read_b64_tr_b16 v[44:45], v12 offset:96
    ds_read_b64_tr_b16 v[46:47], v12 offset:2656
    ds_read_b64_tr_b16 v[48:49], v12 offset:5216
    ds_read_b64_tr_b16 v[50:51], v12 offset:7776
    s_waitcnt lgkmcnt(8)
    v_mfma_f32_16x16x32_bf16 v[100:103], v[84:87], v[28:31], 0
    v_mfma_f32_16x16x32_bf16 v[100:103], v[88:91], v[32:35], v[100:103]
    ds_read_b64_tr_b16 v[52:53], v12 offset:10240
    ds_read_b64_tr_b16 v[54:55], v12 offset:12800
    ds_read_b64_tr_b16 v[56:57], v12 offset:15360
    ds_read_b64_tr_b16 v[58:59], v12 offset:17920
    s_waitcnt lgkmcnt(8)
    v_mfma_f32_16x16x32_bf16 v[104:107], v[84:87], v[36:39], 0
    v_mfma_f32_16x16x32_bf16 v[104:107], v[88:91], v[40:43], v[104:107]
    ds_read_b64_tr_b16 v[60:61], v12 offset:10272
    ds_read_b64_tr_b16 v[62:63], v12 offset:12832
    ds_read_b64_tr_b16 v[64:65], v12 offset:15392
    ds_read_b64_tr_b16 v[66:67], v12 offset:17952
    s_waitcnt lgkmcnt(8)
    v_mfma_f32_16x16x32_bf16 v[108:111], v[84:87], v[44:47], 0
    v_mfma_f32_16x16x32_bf16 v[108:111], v[88:91], v[48:51], v[108:111]
    ds_read_b64_tr_b16 v[68:69], v12 offset:10304
    ds_read_b64_tr_b16 v[70:71], v12 offset:12864
    ds_read_b64_tr_b16 v[72:73], v12 offset:15424
    ds_read_b64_tr_b16 v[74:75], v12 offset:17984
    s_waitcnt lgkmcnt(8)
    v_mfma_f32_16x16x32_bf16 v[20:23], v[84:87], v[52:55], 0
    v_mfma_f32_16x16x32_bf16 v[20:23], v[88:91], v[56:59], v[20:23]
    ds_read_b64_tr_b16 v[76:77], v12 offset:10336
    ds_read_b64_tr_b16 v[78:79], v12 offset:12896
    ds_read_b64_tr_b16 v[80:81], v12 offset:15456
    ds_read_b64_tr_b16 v[82:83], v12 offset:18016
    s_waitcnt lgkmcnt(8)
    v_mfma_f32_16x16x32_bf16 v[24:27], v[84:87], v[60:63], 0
    v_mfma_f32_16x16x32_bf16 v[24:27], v[88:91], v[64:67], v[24:27]
    s_waitcnt lgkmcnt(4)
    v_mfma_f32_16x16x32_bf16 v[28:31], v[84:87], v[68:71], 0
    v_mfma_f32_16x16x32_bf16 v[28:31], v[88:91], v[72:75], v[28:31]
    s_waitcnt lgkmcnt(0)
    v_mfma_f32_16x16x32_bf16 v[32:35], v[84:87], v[76:79], 0
    v_mfma_f32_16x16x32_bf16 v[32:35], v[88:91], v[80:83], v[32:35]
    ds_read_b64 v[92:93], v112 offset:24
    s_waitcnt lgkmcnt(0)
    v_and_b32 v92, -2, v92
    s_barrier
    s_mov_b32 s44, 0x3fb8aa3b
    v_mov_b32 v15, 0xc1300000
    v_lshl_add_u32 v120, v14, 10, v1
    v_lshl_add_u32 v14, v14, 11, v1
    v_add_u32 v13, 76800, v14
    v_fma_f32 v64, v96, s44, v15
    v_fma_f32 v65, v100, s44, v15
    v_fma_f32 v66, v104, s44, v15
    v_fma_f32 v67, v108, s44, v15
    v_fma_f32 v68, v97, s44, v15
    v_fma_f32 v69, v101, s44, v15
    v_fma_f32 v70, v105, s44, v15
    v_fma_f32 v71, v109, s44, v15
    v_fma_f32 v72, v98, s44, v15
    v_fma_f32 v73, v102, s44, v15
    v_fma_f32 v74, v106, s44, v15
    v_fma_f32 v75, v110, s44, v15
    v_fma_f32 v76, v99, s44, v15
    v_fma_f32 v77, v103, s44, v15
    v_fma_f32 v78, v107, s44, v15
    v_fma_f32 v79, v111, s44, v15
    v_exp_f32 v64, v64
    v_exp_f32 v65, v65
    v_exp_f32 v66, v66
    v_exp_f32 v67, v67
    v_exp_f32 v68, v68
    v_exp_f32 v69, v69
    v_exp_f32 v70, v70
    v_exp_f32 v71, v71
    v_exp_f32 v72, v72
    v_exp_f32 v73, v73
    v_exp_f32 v74, v74
    v_exp_f32 v75, v75
    v_exp_f32 v76, v76
    v_exp_f32 v77, v77
    v_exp_f32 v78, v78
    v_exp_f32 v79, v79
    v_mov_b32 v40, v20
    v_mov_b32 v41, v24
    v_mov_b32 v42, v28
    v_mov_b32 v43, v32
    v_mov_b32 v44, v21
    v_mov_b32 v45, v25
    v_mov_b32 v46, v29
    v_mov_b32 v47, v33
    v_mov_b32 v48, v22
    v_mov_b32 v49, v26
    v_mov_b32 v50, v30
    v_mov_b32 v51, v34
    v_mov_b32 v52, v23
    v_mov_b32 v53, v27
    v_mov_b32 v54, v31
    v_mov_b32 v55, v35
    s_sleep 5
    global_load_dwordx2 v[94:95], v115, s[26:27] sc1
    ds_write_b128 v14, v[64:67] offset:44032
    ds_write_b128 v13, v[40:43] offset:0
    ds_write_b128 v14, v[68:71] offset:44544
    ds_write_b128 v13, v[44:47] offset:512
    ds_write_b128 v14, v[72:75] offset:45056
    ds_write_b128 v13, v[48:51] offset:1024
    ds_write_b128 v14, v[76:79] offset:45568
    ds_write_b128 v13, v[52:55] offset:1536
    v_max3_f32 v16, |v96|, |v97|, |v98|
    v_max3_f32 v16, v16, |v99|, |v100|
    v_max3_f32 v16, v16, |v101|, |v102|
    v_max3_f32 v16, v16, |v103|, |v104|
    v_max3_f32 v16, v16, |v105|, |v106|
    v_max3_f32 v16, v16, |v107|, |v108|
    v_max3_f32 v16, v16, |v109|, |v110|
    v_max3_f32 v16, v16, |v110|, |v111|
    v_cmp_nge_f32 vcc, 0x420d66eb, v16
    s_cbranch_vccz L_prep
    v_mov_b32 v16, 1540
    v_mov_b32 v17, 16
    ds_or_b32 v16, v17
L_prep:
    s_setprio 0
    s_mov_b32 s43, 0
    s_mov_b32 s40, 0x1ffffff
    s_mov_b32 s41, 0
    v_and_b32 v9, 3, v0
    v_lshl_add_u32 v6, v9, 4, v114
    v_lshl_add_u32 v20, v9, 2, v114
    v_mul_u32_u24 v5, 12, v9
    v_lshlrev_b32 v4, 2, v9
    v_mul_u32_u24 v3, 3, v9
    v_add_u32 v5, v5, v114
    v_mov_b32 v12, 0
    v_mov_b32 v13, 0
    v_mov_b32 v14, 0
    v_mov_b32 v15, 0
    v_mov_b32 v16, 0
    v_mov_b32 v17, 0
    v_mov_b32 v18, 0
    v_mov_b32 v19, 0
    v_mov_b32 v28, 0
    v_mov_b32 v29, 0
    v_mov_b32 v30, 0
    v_mov_b32 v31, 0
    v_mov_b32 v32, 0
    v_mov_b32 v33, 0
    v_mov_b32 v34, 0
    v_mov_b32 v35, 0
    v_mov_b32 v36, 0
    v_mov_b32 v37, 0
    v_mov_b32 v38, 0
    v_mov_b32 v39, 0
L_poll:
    s_waitcnt vmcnt(0)
    v_xor_b32 v94, v94, v92
    v_xor_b32 v95, v95, v93
    v_cmp_lt_u64 vcc, s[40:41], v[94:95]
    s_cbranch_vccnz L_repoll
L_ready:
    s_mov_b64 exec, -1
    v_and_b32 v10, 0xfff, v94
    v_lshl_add_u32 v6, v10, 2, v6
    v_lshrrev_b32 v2, 12, v94
    v_sub_u32 v11, v2, v4
    v_cmp_lt_i32 vcc, 0, v11
    v_sub_u32 v21, v2, v9
    v_sub_u32 v3, v2, v3
    v_cmp_lt_i32 s[42:43], 16, v21
    v_cmp_lt_i32 s[40:41], 20, v3
    v_lshl_add_u32 v20, v10, 2, v20
    v_lshl_add_u32 v5, v10, 2, v5
    s_mov_b64 exec, vcc
    s_cbranch_execz L_r1
    global_load_dwordx4 v[64:67], v6, s[26:27] sc1
    s_mov_b64 exec, s[42:43]
    s_cbranch_execz L_r1
    global_load_dword v68, v20, s[26:27] offset:64 sc1
    s_mov_b64 exec, s[40:41]
    s_cbranch_execz L_r1
    global_load_dwordx3 v[70:72], v5, s[26:27] offset:80 sc1
L_r1:
    s_mov_b64 exec, -1
    v_cmp_lt_i32 vcc, 32, v2
    s_cbranch_vccnz L_rare
L_rare_back:
    s_waitcnt vmcnt(0)
    v_cmp_lt_i32 s[44:45], 0, v11
    v_alignbit_b32 v74, v64, v64, 25
    v_and_b32 v74, 0x1bc, v74
    s_mov_b64 exec, s[44:45]
    ds_add_rtn_u32 v82, v74, v119 offset:1024
    s_mov_b64 exec, -1
    v_cmp_lt_i32 s[46:47], 1, v11
    v_alignbit_b32 v75, v65, v65, 25
    v_and_b32 v75, 0x1bc, v75
    s_mov_b64 exec, s[46:47]
    ds_add_rtn_u32 v83, v75, v119 offset:1024
    s_mov_b64 exec, -1
    v_cmp_lt_i32 s[48:49], 2, v11
    v_alignbit_b32 v76, v66, v66, 25
    v_and_b32 v76, 0x1bc, v76
    s_mov_b64 exec, s[48:49]
    ds_add_rtn_u32 v84, v76, v119 offset:1024
    s_mov_b64 exec, -1
    v_cmp_lt_i32 s[50:51], 3, v11
    v_alignbit_b32 v77, v67, v67, 25
    v_and_b32 v77, 0x1bc, v77
    s_mov_b64 exec, s[50:51]
    ds_add_rtn_u32 v85, v77, v119 offset:1024
    s_mov_b64 exec, -1
    v_cmp_lt_i32 s[52:53], 16, v21
    v_alignbit_b32 v78, v68, v68, 25
    v_and_b32 v78, 0x1bc, v78
    s_mov_b64 exec, s[52:53]
    ds_add_rtn_u32 v86, v78, v119 offset:1024
    s_mov_b64 exec, -1
    v_and_b32 v74, 0x87ff0000, v64
    v_and_b32 v75, 0x87ff0000, v65
    v_and_b32 v76, 0x87ff0000, v66
    v_and_b32 v77, 0x87ff0000, v67
    v_and_b32 v78, 0x87ff0000, v68
    v_fma_f32 v74, v74, s64, v126
    v_fma_f32 v75, v75, s64, v126
    v_fma_f32 v76, v76, s64, v126
    v_fma_f32 v77, v77, s64, v126
    v_fma_f32 v78, v78, s64, v126
    v_and_b32 v74, 0x7ffe, v74
    v_and_b32 v75, 0x7ffe, v75
    v_and_b32 v76, 0x7ffe, v76
    v_and_b32 v77, 0x7ffe, v77
    v_and_b32 v78, 0x7ffe, v78
    v_lshrrev_b32_sdwa v74, s65, v64 dst_sel:WORD_1 dst_unused:UNUSED_PRESERVE src0_sel:DWORD src1_sel:WORD_0
    v_lshrrev_b32_sdwa v75, s65, v65 dst_sel:WORD_1 dst_unused:UNUSED_PRESERVE src0_sel:DWORD src1_sel:WORD_0
    v_lshrrev_b32_sdwa v76, s65, v66 dst_sel:WORD_1 dst_unused:UNUSED_PRESERVE src0_sel:DWORD src1_sel:WORD_0
    v_lshrrev_b32_sdwa v77, s65, v67 dst_sel:WORD_1 dst_unused:UNUSED_PRESERVE src0_sel:DWORD src1_sel:WORD_0
    v_lshrrev_b32_sdwa v78, s65, v68 dst_sel:WORD_1 dst_unused:UNUSED_PRESERVE src0_sel:DWORD src1_sel:WORD_0
    global_load_dwordx2 v[94:95], v113, s[26:27] sc1
    s_cmp_eq_u64 s[40:41], 0
    s_cbranch_scc1 L_r2
    v_cmp_lt_i32 s[54:55], 20, v3
    v_alignbit_b32 v79, v70, v70, 25
    v_and_b32 v79, 0x1bc, v79
    s_mov_b64 exec, s[54:55]
    ds_add_rtn_u32 v87, v79, v119 offset:1024
    s_mov_b64 exec, -1
    v_cmp_lt_i32 s[56:57], 21, v3
    v_alignbit_b32 v80, v71, v71, 25
    v_and_b32 v80, 0x1bc, v80
    s_mov_b64 exec, s[56:57]
    ds_add_rtn_u32 v88, v80, v119 offset:1024
    s_mov_b64 exec, -1
    v_cmp_lt_i32 s[58:59], 22, v3
    v_alignbit_b32 v81, v72, v72, 25
    v_and_b32 v81, 0x1bc, v81
    s_mov_b64 exec, s[58:59]
    ds_add_rtn_u32 v89, v81, v119 offset:1024
    s_mov_b64 exec, -1
    v_and_b32 v79, 0x87ff0000, v70
    v_and_b32 v80, 0x87ff0000, v71
    v_and_b32 v81, 0x87ff0000, v72
    v_fma_f32 v79, v79, s64, v126
    v_fma_f32 v80, v80, s64, v126
    v_fma_f32 v81, v81, s64, v126
    v_and_b32 v79, 0x7ffe, v79
    v_and_b32 v80, 0x7ffe, v80
    v_and_b32 v81, 0x7ffe, v81
    v_lshrrev_b32_sdwa v79, s65, v70 dst_sel:WORD_1 dst_unused:UNUSED_PRESERVE src0_sel:DWORD src1_sel:WORD_0
    v_lshrrev_b32_sdwa v80, s65, v71 dst_sel:WORD_1 dst_unused:UNUSED_PRESERVE src0_sel:DWORD src1_sel:WORD_0
    v_lshrrev_b32_sdwa v81, s65, v72 dst_sel:WORD_1 dst_unused:UNUSED_PRESERVE src0_sel:DWORD src1_sel:WORD_0
    s_waitcnt lgkmcnt(0)
    s_mov_b64 exec, s[54:55]
    ds_write_b32 v87, v79
    s_mov_b64 exec, s[56:57]
    ds_write_b32 v88, v80
    s_mov_b64 exec, s[58:59]
    ds_write_b32 v89, v81
    s_mov_b64 exec, -1
L_r2:
    s_waitcnt lgkmcnt(0)
    s_mov_b64 exec, s[44:45]
    ds_write_b32 v82, v74
    s_mov_b64 exec, s[46:47]
    ds_write_b32 v83, v75
    s_mov_b64 exec, s[48:49]
    ds_write_b32 v84, v76
    s_mov_b64 exec, s[50:51]
    ds_write_b32 v85, v77
    s_mov_b64 exec, s[52:53]
    ds_write_b32 v86, v78
    s_mov_b64 exec, -1
    s_mov_b32 s43, 0
L_tp:
    s_waitcnt vmcnt(0)
    v_cmp_ne_u64 vcc, v[92:93], v[94:95]
    s_cbranch_vccnz L_tpw
L_b4:
    v_mov_b32 v10, 1540
    s_mov_b32 s50, -1
    s_mov_b32 s51, 0x1ffff
    s_mov_b32 s48, 0x00010001
    s_mov_b32 s49, 0x00010001
    s_mov_b32 s40, 0x7f00
    s_mov_b32 s41, 0x0c0c0400
    s_setprio 3
    s_waitcnt lgkmcnt(0)
    s_barrier
    s_lshr_b32 s42, s2, 3
    s_lshl_b32 s42, s42, 4
    s_add_u32 s42, s42, s3
    s_mul_i32 s42, s42, 6272
    v_lshlrev_b32 v11, 7, v116
    s_mov_b64 exec, 0x3f
    buffer_load_dword v113, v11, s[32:35], s42 offen
    s_mov_b64 exec, -1
    ds_read_b32 v121, v117 offset:1024
    ds_read_b32 v122, v10
    s_waitcnt lgkmcnt(0)
    ds_write2_b32 v121, v12, v12 offset0:0 offset1:1
    ds_write2_b32 v121, v12, v12 offset0:2 offset1:3
    v_sub_u32 v121, v121, v118
    v_cmp_lt_u32 vcc, 512, v121
    s_or_b64 s[62:63], s[62:63], vcc
    v_cmp_ne_u32 vcc, 0, v122
    v_add_u32 v121, 12, v121
    v_lshrrev_b32 v121, 4, v121
    v_max_u32 v121, 1, v121
    s_or_b64 s[62:63], s[62:63], vcc
    s_cbranch_scc1 L_slow
    v_cndmask_b32 v121, 0, v121, s[50:51]
    s_nop 1
    v_add_u32_dpp v122, v121, v121 row_shr:1 row_mask:0xf bank_mask:0xf bound_ctrl:0
    s_nop 1
    v_add_u32_dpp v122, v122, v122 row_shr:2 row_mask:0xf bank_mask:0xf bound_ctrl:0
    s_nop 1
    v_add_u32_dpp v122, v122, v122 row_shr:4 row_mask:0xf bank_mask:0xf bound_ctrl:0
    s_nop 1
    v_add_u32_dpp v122, v122, v122 row_shr:8 row_mask:0xf bank_mask:0xf bound_ctrl:0
    s_nop 1
    v_add_u32_dpp v122, v122, v122 row_bcast:15 row_mask:0xa bank_mask:0xf
    s_nop 1
    v_add_u32_dpp v122, v122, v122 row_bcast:31 row_mask:0xc bank_mask:0xf
    s_nop 0
    v_readlane_b32 s42, v122, 63
    v_sub_u32 v121, v122, v121
    v_lshlrev_b32 v124, 4, v121
    v_sub_u32 v124, v118, v124
    s_cmp_gt_u32 s42, 1024
    s_cbranch_scc1 L_slow
    s_add_u32 s42, s42, 3
    s_lshr_b32 s43, s42, 6
    s_bfe_u32 s44, s42, 0x40002
    s_cmp_lt_u32 s3, s44
    s_addc_u32 s45, s43, 0
    s_mul_i32 s46, s3, s43
    s_min_u32 s47, s3, s44
    s_add_u32 s46, s46, s47
    s_lshl_b32 s46, s46, 2
    s_lshl_b32 s47, s45, 2
    v_subrev_u32 v123, s46, v121
    v_cmp_gt_u32 vcc, s47, v123
    v_lshlrev_b32 v123, 2, v123
    s_and_b32 vcc_hi, vcc_hi, 0x3ffff
    v_cndmask_b32 v123, 0, v123, vcc
    ds_permute_b32 v125, v123, v119
    v_cmp_ge_u32 vcc, s46, v122
    s_lshl_b32 s56, s46, 4
    s_and_b64 vcc, vcc, s[50:51]
    s_bcnt1_i32_b64 s52, vcc
    v_readlane_b32 s47, v124, s52
    s_add_u32 s56, s56, s47
    s_add_u32 s46, s46, s45
    v_cmp_ge_u32 vcc, s46, v122
    s_lshl_b32 s57, s46, 4
    s_and_b64 vcc, vcc, s[50:51]
    s_bcnt1_i32_b64 s53, vcc
    v_readlane_b32 s47, v124, s53
    s_add_u32 s57, s57, s47
    s_add_u32 s46, s46, s45
    v_cmp_ge_u32 vcc, s46, v122
    s_lshl_b32 s58, s46, 4
    s_and_b64 vcc, vcc, s[50:51]
    s_bcnt1_i32_b64 s54, vcc
    v_readlane_b32 s47, v124, s54
    s_add_u32 s58, s58, s47
    s_add_u32 s46, s46, s45
    v_cmp_ge_u32 vcc, s46, v122
    s_lshl_b32 s59, s46, 4
    s_and_b64 vcc, vcc, s[50:51]
    s_bcnt1_i32_b64 s55, vcc
    v_readlane_b32 s47, v124, s55
    s_add_u32 s59, s59, s47
    v_mov_b32 v80, s56
    v_mov_b32 v81, s52
    s_mov_b32 exec_lo, 0xffff0000
    v_mov_b32 v80, s57
    v_mov_b32 v81, s53
    s_mov_b32 exec_lo, 0
    v_mov_b32 v80, s58
    v_mov_b32 v81, s54
    s_mov_b32 exec_hi, 0xffff0000
    v_mov_b32 v80, s59
    v_mov_b32 v81, s55
    s_mov_b64 exec, -1
    s_cmp_eq_u32 s45, 0
    s_cbranch_scc1 L_done
    ds_read_b128 v[40:43], v80
    v_lshl_add_u32 v82, v81, 9, v1
    s_mov_b32 s44, 0x0c070600
    ds_read_b128 v[8:11], v82 offset:44032
    v_mul_u32_u24 v81, 528, v81
    v_add_u32 v81, 134912, v81
    v_add_u32 v82, 44544, v82
    s_waitcnt lgkmcnt(1)
    v_perm_b32 v84, v40, v1, s44
    v_perm_b32 v85, v41, v1, s44
    buffer_load_dwordx4 v[64:67], v84, s[32:35], 0 offen
    buffer_load_dwordx4 v[68:71], v85, s[32:35], 0 offen
    v_perm_b32 v84, v42, v1, s44
    v_perm_b32 v85, v43, v1, s44
    buffer_load_dwordx4 v[72:75], v84, s[32:35], 0 offen
    buffer_load_dwordx4 v[76:79], v85, s[32:35], 0 offen
    v_and_or_b32 v44, v40, s40, v1
    v_and_or_b32 v45, v41, s40, v1
    v_perm_b32 v46, v40, v1, s41
    v_perm_b32 v47, v41, v1, s41
    ds_read_b128 v[48:51], v44 offset:11008
    ds_read_b128 v[52:55], v45 offset:11008
    ds_read_b128 v[56:59], v46 offset:43776
    ds_read_b128 v[60:63], v47 offset:43776
    v_cmp_ne_u32 s[42:43], 0, v125
    s_mov_b32 s50, 0x00030003
    s_mov_b32 s51, 0x00030003
    s_lshr_b64 s[52:53], s[42:43], s45
    s_lshr_b64 s[54:55], s[52:53], s45
    s_lshr_b64 s[56:57], s[54:55], s45
    s_pack_ll_b32_b16 s42, s42, s52
    s_pack_ll_b32_b16 s43, s54, s56
    s_andn2_b64 s[42:43], s[42:43], s[48:49]
    s_setprio 1
L_ph0:
    s_cmp_le_u32 s45, 5
    s_cbranch_scc1 L_ph1
L_loop0:
    s_setprio 0
    v_fmac_f32 v12, v32, v28
    v_fmac_f32 v13, v33, v29
    v_fmac_f32 v14, v34, v30
    v_fmac_f32 v15, v35, v31
    v_fmac_f32 v16, v36, v28
    v_fmac_f32 v17, v37, v29
    v_fmac_f32 v18, v38, v30
    v_fmac_f32 v19, v39, v31
    s_setprio 3
    s_and_b64 s[46:47], s[42:43], s[50:51]
    s_cbranch_scc1 L_evt_b0
L_eback_b0:
    s_lshr_b64 s[42:43], s[42:43], 1
    s_waitcnt lgkmcnt(0)
    v_pk_mul_f32 v[20:21], v[48:49], v[56:57]
    v_pk_mul_f32 v[22:23], v[50:51], v[58:59]
    v_pk_mul_f32 v[24:25], v[52:53], v[60:61]
    v_pk_mul_f32 v[26:27], v[54:55], v[62:63]
    v_and_or_b32 v44, v42, s40, v1
    v_and_or_b32 v45, v43, s40, v1
    v_perm_b32 v46, v42, v1, s41
    v_perm_b32 v47, v43, v1, s41
    ds_read_b128 v[48:51], v44 offset:11008
    ds_read_b128 v[52:55], v45 offset:11008
    ds_read_b128 v[56:59], v46 offset:43776
    ds_read_b128 v[60:63], v47 offset:43776
    ds_read_b128 v[40:43], v80 offset:16
    s_waitcnt vmcnt(2)
    v_pk_fma_f32 v[20:21], v[20:21], v[64:65], v[8:9]
    v_pk_fma_f32 v[22:23], v[22:23], v[66:67], v[10:11]
    v_pk_fma_f32 v[24:25], v[24:25], v[68:69], v[8:9]
    v_pk_fma_f32 v[26:27], v[26:27], v[70:71], v[10:11]
    v_pk_mul_f32 v[28:29], v[20:21], v[24:25]
    v_pk_mul_f32 v[30:31], v[22:23], v[26:27]
    v_fma_mix_f32 v36, v24, v64, 0 op_sel_hi:[0,1,0]
    v_fma_mix_f32 v37, v25, v65, 0 op_sel_hi:[0,1,0]
    v_fma_mix_f32 v38, v26, v66, 0 op_sel_hi:[0,1,0]
    v_fma_mix_f32 v39, v27, v67, 0 op_sel_hi:[0,1,0]
    v_fma_mix_f32 v36, v20, v68, v36 op_sel_hi:[0,1,0]
    v_fma_mix_f32 v37, v21, v69, v37 op_sel_hi:[0,1,0]
    v_fma_mix_f32 v38, v22, v70, v38 op_sel_hi:[0,1,0]
    v_fma_mix_f32 v39, v23, v71, v39 op_sel_hi:[0,1,0]
    s_waitcnt lgkmcnt(0)
    v_perm_b32 v84, v40, v1, s44
    v_perm_b32 v85, v41, v1, s44
    buffer_load_dwordx4 v[64:67], v84, s[32:35], 0 offen
    buffer_load_dwordx4 v[68:71], v85, s[32:35], 0 offen
    v_rcp_f32 v28, v28
    v_rcp_f32 v29, v29
    v_rcp_f32 v30, v30
    v_rcp_f32 v31, v31
    v_pk_add_f32 v[32:33], v[20:21], v[24:25]
    v_pk_add_f32 v[34:35], v[22:23], v[26:27]
    s_setprio 0
    v_fmac_f32 v12, v32, v28
    v_fmac_f32 v13, v33, v29
    v_fmac_f32 v14, v34, v30
    v_fmac_f32 v15, v35, v31
    v_fmac_f32 v16, v36, v28
    v_fmac_f32 v17, v37, v29
    v_fmac_f32 v18, v38, v30
    v_fmac_f32 v19, v39, v31
    s_setprio 3
    v_pk_mul_f32 v[20:21], v[48:49], v[56:57]
    v_pk_mul_f32 v[22:23], v[50:51], v[58:59]
    v_pk_mul_f32 v[24:25], v[52:53], v[60:61]
    v_pk_mul_f32 v[26:27], v[54:55], v[62:63]
    v_and_or_b32 v44, v40, s40, v1
    v_and_or_b32 v45, v41, s40, v1
    v_perm_b32 v46, v40, v1, s41
    v_perm_b32 v47, v41, v1, s41
    ds_read_b128 v[48:51], v44 offset:11008
    ds_read_b128 v[52:55], v45 offset:11008
    ds_read_b128 v[56:59], v46 offset:43776
    ds_read_b128 v[60:63], v47 offset:43776
    v_add_u32 v80, 16, v80
    s_waitcnt vmcnt(2)
    v_pk_fma_f32 v[20:21], v[20:21], v[72:73], v[8:9]
    v_pk_fma_f32 v[22:23], v[22:23], v[74:75], v[10:11]
    v_pk_fma_f32 v[24:25], v[24:25], v[76:77], v[8:9]
    v_pk_fma_f32 v[26:27], v[26:27], v[78:79], v[10:11]
    v_pk_mul_f32 v[28:29], v[20:21], v[24:25]
    v_pk_mul_f32 v[30:31], v[22:23], v[26:27]
    v_fma_mix_f32 v36, v24, v72, 0 op_sel_hi:[0,1,0]
    v_fma_mix_f32 v37, v25, v73, 0 op_sel_hi:[0,1,0]
    v_fma_mix_f32 v38, v26, v74, 0 op_sel_hi:[0,1,0]
    v_fma_mix_f32 v39, v27, v75, 0 op_sel_hi:[0,1,0]
    v_fma_mix_f32 v36, v20, v76, v36 op_sel_hi:[0,1,0]
    v_fma_mix_f32 v37, v21, v77, v37 op_sel_hi:[0,1,0]
    v_fma_mix_f32 v38, v22, v78, v38 op_sel_hi:[0,1,0]
    v_fma_mix_f32 v39, v23, v79, v39 op_sel_hi:[0,1,0]
    v_perm_b32 v84, v42, v1, s44
    v_perm_b32 v85, v43, v1, s44
    buffer_load_dwordx4 v[72:75], v84, s[32:35], 0 offen
    buffer_load_dwordx4 v[76:79], v85, s[32:35], 0 offen
    v_rcp_f32 v28, v28
    v_rcp_f32 v29, v29
    v_rcp_f32 v30, v30
    v_rcp_f32 v31, v31
    v_pk_add_f32 v[32:33], v[20:21], v[24:25]
    v_pk_add_f32 v[34:35], v[22:23], v[26:27]
    s_sub_u32 s45, s45, 1
    s_cmp_gt_u32 s45, 5
    s_cbranch_scc1 L_loop0
L_ph1:
    s_cmp_le_u32 s45, 2
    s_cbranch_scc1 L_ph2
L_loop1:
    s_setprio 0
    v_fmac_f32 v12, v32, v28
    v_fmac_f32 v13, v33, v29
    v_fmac_f32 v14, v34, v30
    v_fmac_f32 v15, v35, v31
    v_fmac_f32 v16, v36, v28
    v_fmac_f32 v17, v37, v29
    v_fmac_f32 v18, v38, v30
    v_fmac_f32 v19, v39, v31
    s_setprio 2
    s_and_b64 s[46:47], s[42:43], s[50:51]
    s_cbranch_scc1 L_evt_b1
L_eback_b1:
    s_lshr_b64 s[42:43], s[42:43], 1
    s_waitcnt lgkmcnt(0)
    v_pk_mul_f32 v[20:21], v[48:49], v[56:57]
    v_pk_mul_f32 v[22:23], v[50:51], v[58:59]
    v_pk_mul_f32 v[24:25], v[52:53], v[60:61]
    v_pk_mul_f32 v[26:27], v[54:55], v[62:63]
    v_and_or_b32 v44, v42, s40, v1
    v_and_or_b32 v45, v43, s40, v1
    v_perm_b32 v46, v42, v1, s41
    v_perm_b32 v47, v43, v1, s41
    ds_read_b128 v[48:51], v44 offset:11008
    ds_read_b128 v[52:55], v45 offset:11008
    ds_read_b128 v[56:59], v46 offset:43776
    ds_read_b128 v[60:63], v47 offset:43776
    ds_read_b128 v[40:43], v80 offset:16
    s_waitcnt vmcnt(2)
    v_pk_fma_f32 v[20:21], v[20:21], v[64:65], v[8:9]
    v_pk_fma_f32 v[22:23], v[22:23], v[66:67], v[10:11]
    v_pk_fma_f32 v[24:25], v[24:25], v[68:69], v[8:9]
    v_pk_fma_f32 v[26:27], v[26:27], v[70:71], v[10:11]
    v_pk_mul_f32 v[28:29], v[20:21], v[24:25]
    v_pk_mul_f32 v[30:31], v[22:23], v[26:27]
    v_fma_mix_f32 v36, v24, v64, 0 op_sel_hi:[0,1,0]
    v_fma_mix_f32 v37, v25, v65, 0 op_sel_hi:[0,1,0]
    v_fma_mix_f32 v38, v26, v66, 0 op_sel_hi:[0,1,0]
    v_fma_mix_f32 v39, v27, v67, 0 op_sel_hi:[0,1,0]
    v_fma_mix_f32 v36, v20, v68, v36 op_sel_hi:[0,1,0]
    v_fma_mix_f32 v37, v21, v69, v37 op_sel_hi:[0,1,0]
    v_fma_mix_f32 v38, v22, v70, v38 op_sel_hi:[0,1,0]
    v_fma_mix_f32 v39, v23, v71, v39 op_sel_hi:[0,1,0]
    s_waitcnt lgkmcnt(0)
    v_perm_b32 v84, v40, v1, s44
    v_perm_b32 v85, v41, v1, s44
    buffer_load_dwordx4 v[64:67], v84, s[32:35], 0 offen
    buffer_load_dwordx4 v[68:71], v85, s[32:35], 0 offen
    v_rcp_f32 v28, v28
    v_rcp_f32 v29, v29
    v_rcp_f32 v30, v30
    v_rcp_f32 v31, v31
    v_pk_add_f32 v[32:33], v[20:21], v[24:25]
    v_pk_add_f32 v[34:35], v[22:23], v[26:27]
    s_setprio 0
    v_fmac_f32 v12, v32, v28
    v_fmac_f32 v13, v33, v29
    v_fmac_f32 v14, v34, v30
    v_fmac_f32 v15, v35, v31
    v_fmac_f32 v16, v36, v28
    v_fmac_f32 v17, v37, v29
    v_fmac_f32 v18, v38, v30
    v_fmac_f32 v19, v39, v31
    s_setprio 2
    v_pk_mul_f32 v[20:21], v[48:49], v[56:57]
    v_pk_mul_f32 v[22:23], v[50:51], v[58:59]
    v_pk_mul_f32 v[24:25], v[52:53], v[60:61]
    v_pk_mul_f32 v[26:27], v[54:55], v[62:63]
    v_and_or_b32 v44, v40, s40, v1
    v_and_or_b32 v45, v41, s40, v1
    v_perm_b32 v46, v40, v1, s41
    v_perm_b32 v47, v41, v1, s41
    ds_read_b128 v[48:51], v44 offset:11008
    ds_read_b128 v[52:55], v45 offset:11008
    ds_read_b128 v[56:59], v46 offset:43776
    ds_read_b128 v[60:63], v47 offset:43776
    v_add_u32 v80, 16, v80
    s_waitcnt vmcnt(2)
    v_pk_fma_f32 v[20:21], v[20:21], v[72:73], v[8:9]
    v_pk_fma_f32 v[22:23], v[22:23], v[74:75], v[10:11]
    v_pk_fma_f32 v[24:25], v[24:25], v[76:77], v[8:9]
    v_pk_fma_f32 v[26:27], v[26:27], v[78:79], v[10:11]
    v_pk_mul_f32 v[28:29], v[20:21], v[24:25]
    v_pk_mul_f32 v[30:31], v[22:23], v[26:27]
    v_fma_mix_f32 v36, v24, v72, 0 op_sel_hi:[0,1,0]
    v_fma_mix_f32 v37, v25, v73, 0 op_sel_hi:[0,1,0]
    v_fma_mix_f32 v38, v26, v74, 0 op_sel_hi:[0,1,0]
    v_fma_mix_f32 v39, v27, v75, 0 op_sel_hi:[0,1,0]
    v_fma_mix_f32 v36, v20, v76, v36 op_sel_hi:[0,1,0]
    v_fma_mix_f32 v37, v21, v77, v37 op_sel_hi:[0,1,0]
    v_fma_mix_f32 v38, v22, v78, v38 op_sel_hi:[0,1,0]
    v_fma_mix_f32 v39, v23, v79, v39 op_sel_hi:[0,1,0]
    v_perm_b32 v84, v42, v1, s44
    v_perm_b32 v85, v43, v1, s44
    buffer_load_dwordx4 v[72:75], v84, s[32:35], 0 offen
    buffer_load_dwordx4 v[76:79], v85, s[32:35], 0 offen
    v_rcp_f32 v28, v28
    v_rcp_f32 v29, v29
    v_rcp_f32 v30, v30
    v_rcp_f32 v31, v31
    v_pk_add_f32 v[32:33], v[20:21], v[24:25]
    v_pk_add_f32 v[34:35], v[22:23], v[26:27]
    s_sub_u32 s45, s45, 1
    s_cmp_gt_u32 s45, 2
    s_cbranch_scc1 L_loop1
L_ph2:
    s_cmp_le_u32 s45, 1
    s_cbranch_scc1 L_last
L_loop2:
    s_setprio 0
    v_fmac_f32 v12, v32, v28
    v_fmac_f32 v13, v33, v29
    v_fmac_f32 v14, v34, v30
    v_fmac_f32 v15, v35, v31
    v_fmac_f32 v16, v36, v28
    v_fmac_f32 v17, v37, v29
    v_fmac_f32 v18, v38, v30
    v_fmac_f32 v19, v39, v31
    s_setprio 1
    s_and_b64 s[46:47], s[42:43], s[50:51]
    s_cbranch_scc1 L_evt_b2
L_eback_b2:
    s_lshr_b64 s[42:43], s[42:43], 1
    s_waitcnt lgkmcnt(0)
    v_pk_mul_f32 v[20:21], v[48:49], v[56:57]
    v_pk_mul_f32 v[22:23], v[50:51], v[58:59]
    v_pk_mul_f32 v[24:25], v[52:53], v[60:61]
    v_pk_mul_f32 v[26:27], v[54:55], v[62:63]
    v_and_or_b32 v44, v42, s40, v1
    v_and_or_b32 v45, v43, s40, v1
    v_perm_b32 v46, v42, v1, s41
    v_perm_b32 v47, v43, v1, s41
    ds_read_b128 v[48:51], v44 offset:11008
    ds_read_b128 v[52:55], v45 offset:11008
    ds_read_b128 v[56:59], v46 offset:43776
    ds_read_b128 v[60:63], v47 offset:43776
    ds_read_b128 v[40:43], v80 offset:16
    s_waitcnt vmcnt(2)
    v_pk_fma_f32 v[20:21], v[20:21], v[64:65], v[8:9]
    v_pk_fma_f32 v[22:23], v[22:23], v[66:67], v[10:11]
    v_pk_fma_f32 v[24:25], v[24:25], v[68:69], v[8:9]
    v_pk_fma_f32 v[26:27], v[26:27], v[70:71], v[10:11]
    v_pk_mul_f32 v[28:29], v[20:21], v[24:25]
    v_pk_mul_f32 v[30:31], v[22:23], v[26:27]
    v_fma_mix_f32 v36, v24, v64, 0 op_sel_hi:[0,1,0]
    v_fma_mix_f32 v37, v25, v65, 0 op_sel_hi:[0,1,0]
    v_fma_mix_f32 v38, v26, v66, 0 op_sel_hi:[0,1,0]
    v_fma_mix_f32 v39, v27, v67, 0 op_sel_hi:[0,1,0]
    v_fma_mix_f32 v36, v20, v68, v36 op_sel_hi:[0,1,0]
    v_fma_mix_f32 v37, v21, v69, v37 op_sel_hi:[0,1,0]
    v_fma_mix_f32 v38, v22, v70, v38 op_sel_hi:[0,1,0]
    v_fma_mix_f32 v39, v23, v71, v39 op_sel_hi:[0,1,0]
    s_waitcnt lgkmcnt(0)
    v_perm_b32 v84, v40, v1, s44
    v_perm_b32 v85, v41, v1, s44
    buffer_load_dwordx4 v[64:67], v84, s[32:35], 0 offen
    buffer_load_dwordx4 v[68:71], v85, s[32:35], 0 offen
    v_rcp_f32 v28, v28
    v_rcp_f32 v29, v29
    v_rcp_f32 v30, v30
    v_rcp_f32 v31, v31
    v_pk_add_f32 v[32:33], v[20:21], v[24:25]
    v_pk_add_f32 v[34:35], v[22:23], v[26:27]
    s_setprio 0
    v_fmac_f32 v12, v32, v28
    v_fmac_f32 v13, v33, v29
    v_fmac_f32 v14, v34, v30
    v_fmac_f32 v15, v35, v31
    v_fmac_f32 v16, v36, v28
    v_fmac_f32 v17, v37, v29
    v_fmac_f32 v18, v38, v30
    v_fmac_f32 v19, v39, v31
    s_setprio 1
    v_pk_mul_f32 v[20:21], v[48:49], v[56:57]
    v_pk_mul_f32 v[22:23], v[50:51], v[58:59]
    v_pk_mul_f32 v[24:25], v[52:53], v[60:61]
    v_pk_mul_f32 v[26:27], v[54:55], v[62:63]
    v_and_or_b32 v44, v40, s40, v1
    v_and_or_b32 v45, v41, s40, v1
    v_perm_b32 v46, v40, v1, s41
    v_perm_b32 v47, v41, v1, s41
    ds_read_b128 v[48:51], v44 offset:11008
    ds_read_b128 v[52:55], v45 offset:11008
    ds_read_b128 v[56:59], v46 offset:43776
    ds_read_b128 v[60:63], v47 offset:43776
    v_add_u32 v80, 16, v80
    s_waitcnt vmcnt(2)
    v_pk_fma_f32 v[20:21], v[20:21], v[72:73], v[8:9]
    v_pk_fma_f32 v[22:23], v[22:23], v[74:75], v[10:11]
    v_pk_fma_f32 v[24:25], v[24:25], v[76:77], v[8:9]
    v_pk_fma_f32 v[26:27], v[26:27], v[78:79], v[10:11]
    v_pk_mul_f32 v[28:29], v[20:21], v[24:25]
    v_pk_mul_f32 v[30:31], v[22:23], v[26:27]
    v_fma_mix_f32 v36, v24, v72, 0 op_sel_hi:[0,1,0]
    v_fma_mix_f32 v37, v25, v73, 0 op_sel_hi:[0,1,0]
    v_fma_mix_f32 v38, v26, v74, 0 op_sel_hi:[0,1,0]
    v_fma_mix_f32 v39, v27, v75, 0 op_sel_hi:[0,1,0]
    v_fma_mix_f32 v36, v20, v76, v36 op_sel_hi:[0,1,0]
    v_fma_mix_f32 v37, v21, v77, v37 op_sel_hi:[0,1,0]
    v_fma_mix_f32 v38, v22, v78, v38 op_sel_hi:[0,1,0]
    v_fma_mix_f32 v39, v23, v79, v39 op_sel_hi:[0,1,0]
    v_perm_b32 v84, v42, v1, s44
    v_perm_b32 v85, v43, v1, s44
    buffer_load_dwordx4 v[72:75], v84, s[32:35], 0 offen
    buffer_load_dwordx4 v[76:79], v85, s[32:35], 0 offen
    v_rcp_f32 v28, v28
    v_rcp_f32 v29, v29
    v_rcp_f32 v30, v30
    v_rcp_f32 v31, v31
    v_pk_add_f32 v[32:33], v[20:21], v[24:25]
    v_pk_add_f32 v[34:35], v[22:23], v[26:27]
    s_sub_u32 s45, s45, 1
    s_cmp_gt_u32 s45, 1
    s_cbranch_scc1 L_loop2
L_last:
    s_setprio 0
    v_fmac_f32 v12, v32, v28
    v_fmac_f32 v13, v33, v29
    v_fmac_f32 v14, v34, v30
    v_fmac_f32 v15, v35, v31
    v_fmac_f32 v16, v36, v28
    v_fmac_f32 v17, v37, v29
    v_fmac_f32 v18, v38, v30
    v_fmac_f32 v19, v39, v31
    s_setprio 1
    s_and_b64 s[46:47], s[42:43], s[50:51]
    s_cbranch_scc1 L_evt_z
L_eback_z:
    s_waitcnt lgkmcnt(0)
    v_pk_mul_f32 v[20:21], v[48:49], v[56:57]
    v_pk_mul_f32 v[22:23], v[50:51], v[58:59]
    v_pk_mul_f32 v[24:25], v[52:53], v[60:61]
    v_pk_mul_f32 v[26:27], v[54:55], v[62:63]
    v_and_or_b32 v44, v42, s40, v1
    v_and_or_b32 v45, v43, s40, v1
    v_perm_b32 v46, v42, v1, s41
    v_perm_b32 v47, v43, v1, s41
    ds_read_b128 v[48:51], v44 offset:11008
    ds_read_b128 v[52:55], v45 offset:11008
    ds_read_b128 v[56:59], v46 offset:43776
    ds_read_b128 v[60:63], v47 offset:43776
    s_waitcnt vmcnt(2)
    v_pk_fma_f32 v[20:21], v[20:21], v[64:65], v[8:9]
    v_pk_fma_f32 v[22:23], v[22:23], v[66:67], v[10:11]
    v_pk_fma_f32 v[24:25], v[24:25], v[68:69], v[8:9]
    v_pk_fma_f32 v[26:27], v[26:27], v[70:71], v[10:11]
    v_pk_mul_f32 v[28:29], v[20:21], v[24:25]
    v_pk_mul_f32 v[30:31], v[22:23], v[26:27]
    v_fma_mix_f32 v36, v24, v64, 0 op_sel_hi:[0,1,0]
    v_fma_mix_f32 v37, v25, v65, 0 op_sel_hi:[0,1,0]
    v_fma_mix_f32 v38, v26, v66, 0 op_sel_hi:[0,1,0]
    v_fma_mix_f32 v39, v27, v67, 0 op_sel_hi:[0,1,0]
    v_fma_mix_f32 v36, v20, v68, v36 op_sel_hi:[0,1,0]
    v_fma_mix_f32 v37, v21, v69, v37 op_sel_hi:[0,1,0]
    v_fma_mix_f32 v38, v22, v70, v38 op_sel_hi:[0,1,0]
    v_fma_mix_f32 v39, v23, v71, v39 op_sel_hi:[0,1,0]
    s_waitcnt lgkmcnt(0)
    v_rcp_f32 v28, v28
    v_rcp_f32 v29, v29
    v_rcp_f32 v30, v30
    v_rcp_f32 v31, v31
    v_pk_add_f32 v[32:33], v[20:21], v[24:25]
    v_pk_add_f32 v[34:35], v[22:23], v[26:27]
    s_setprio 0
    v_fmac_f32 v12, v32, v28
    v_fmac_f32 v13, v33, v29
    v_fmac_f32 v14, v34, v30
    v_fmac_f32 v15, v35, v31
    v_fmac_f32 v16, v36, v28
    v_fmac_f32 v17, v37, v29
    v_fmac_f32 v18, v38, v30
    v_fmac_f32 v19, v39, v31
    s_setprio 1
    v_pk_mul_f32 v[20:21], v[48:49], v[56:57]
    v_pk_mul_f32 v[22:23], v[50:51], v[58:59]
    v_pk_mul_f32 v[24:25], v[52:53], v[60:61]
    v_pk_mul_f32 v[26:27], v[54:55], v[62:63]
    s_waitcnt vmcnt(0)
    v_pk_fma_f32 v[20:21], v[20:21], v[72:73], v[8:9]
    v_pk_fma_f32 v[22:23], v[22:23], v[74:75], v[10:11]
    v_pk_fma_f32 v[24:25], v[24:25], v[76:77], v[8:9]
    v_pk_fma_f32 v[26:27], v[26:27], v[78:79], v[10:11]
    v_pk_mul_f32 v[28:29], v[20:21], v[24:25]
    v_pk_mul_f32 v[30:31], v[22:23], v[26:27]
    v_fma_mix_f32 v36, v24, v72, 0 op_sel_hi:[0,1,0]
    v_fma_mix_f32 v37, v25, v73, 0 op_sel_hi:[0,1,0]
    v_fma_mix_f32 v38, v26, v74, 0 op_sel_hi:[0,1,0]
    v_fma_mix_f32 v39, v27, v75, 0 op_sel_hi:[0,1,0]
    v_fma_mix_f32 v36, v20, v76, v36 op_sel_hi:[0,1,0]
    v_fma_mix_f32 v37, v21, v77, v37 op_sel_hi:[0,1,0]
    v_fma_mix_f32 v38, v22, v78, v38 op_sel_hi:[0,1,0]
    v_fma_mix_f32 v39, v23, v79, v39 op_sel_hi:[0,1,0]
    v_rcp_f32 v28, v28
    v_rcp_f32 v29, v29
    v_rcp_f32 v30, v30
    v_rcp_f32 v31, v31
    v_pk_add_f32 v[32:33], v[20:21], v[24:25]
    v_pk_add_f32 v[34:35], v[22:23], v[26:27]
    s_setprio 0
    v_fmac_f32 v12, v32, v28
    v_fmac_f32 v13, v33, v29
    v_fmac_f32 v14, v34, v30
    v_fmac_f32 v15, v35, v31
    v_fmac_f32 v16, v36, v28
    v_fmac_f32 v17, v37, v29
    v_fmac_f32 v18, v38, v30
    v_fmac_f32 v19, v39, v31
    s_setprio 1
    s_setprio 0
    v_subrev_u32 v20, 44544, v82
    v_lshrrev_b32 v20, 6, v20
    v_lshlrev_b32 v21, 5, v0
    v_add_u32 v21, 11008, v21
    s_mov_b64 exec, s[48:49]
    ds_max_u32 v20, v21 offset:1792
    ds_min_u32 v20, v21 offset:1796
    s_mov_b64 exec, -1
L_done:
L_epi:
    v_lshrrev_b32 v24, 4, v0
    v_lshl_add_u32 v25, v24, 9, v1
    v_add_u32 v26, 76800, v25
    v_lshlrev_b32 v30, 3, v0
    v_lshlrev_b32 v24, 3, v24
    v_add_u32 v31, v24, v30
    s_lshl_b32 s45, s60, 7
    ds_read_b64 v[2:3], v31 offset:2304
    ds_read_b128 v[40:43], v26
    ds_read_b128 v[56:59], v25 offset:44032
    v_add_u32 v26, 109312, v25
    s_mov_b32 s44, 0x388637bd
    s_mov_b32 s43, 0x42800000
    s_waitcnt lgkmcnt(0)
    s_barrier
    ds_write_b128 v25, v[16:19] offset:11008
    ds_write_b128 v25, v[12:15] offset:11264
    ds_read_b64 v[28:29], v24 offset:1792
    ds_read_b128 v[32:35], v26
    ds_read_b128 v[36:39], v26 offset:256
    v_rcp_f32 v56, v56
    v_rcp_f32 v57, v57
    v_rcp_f32 v58, v58
    v_rcp_f32 v59, v59
    v_lshlrev_b32 v44, 16, v2
    v_and_b32 v45, 0xffff0000, v2
    v_lshlrev_b32 v46, 16, v3
    v_and_b32 v47, 0xffff0000, v3
    v_mul_f32 v56, s44, v56
    v_mul_f32 v57, s44, v57
    v_mul_f32 v58, s44, v58
    v_mul_f32 v59, s44, v59
    v_cmp_gt_u32 vcc, 784, v0
    s_and_b64 exec, exec, vcc
    s_mov_b64 s[46:47], exec
    s_waitcnt lgkmcnt(0)
    v_min_u32 v28, 43264, v28
    v_add_u32 v27, v29, v1
    s_barrier
    s_cbranch_execz L_fin
L_el:
    v_cmp_le_u32 vcc, v29, v28
    s_and_b64 exec, exec, vcc
    s_cbranch_execz L_el_done
    ds_read_b128 v[48:51], v27
    ds_read_b128 v[52:55], v27 offset:256
    v_add_u32 v27, 512, v27
    v_add_u32 v29, 512, v29
    s_waitcnt lgkmcnt(0)
    v_pk_add_f32 v[32:33], v[32:33], v[48:49]
    v_pk_add_f32 v[34:35], v[34:35], v[50:51]
    v_pk_add_f32 v[36:37], v[36:37], v[52:53]
    v_pk_add_f32 v[38:39], v[38:39], v[54:55]
    s_branch L_el
L_el_done:
    s_mov_b64 exec, s[46:47]
    v_fma_f32 v36, v36, s43, v56
    v_fma_f32 v37, v37, s43, v57
    v_fma_f32 v38, v38, s43, v58
    v_fma_f32 v39, v39, s43, v59
    v_rcp_f32 v36, v36
    v_rcp_f32 v37, v37
    v_rcp_f32 v38, v38
    v_rcp_f32 v39, v39
    s_nop 0
    v_fmac_f32 v40, v32, v36
    v_fmac_f32 v41, v33, v37
    v_fmac_f32 v42, v34, v38
    v_fmac_f32 v43, v35, v39
    v_mul_f32 v32, 0, v40
    v_mul_f32 v33, 0, v41
    v_mul_f32 v34, 0, v42
    v_mul_f32 v35, 0, v43
    v_max_f32 v40, v40, v32
    v_max_f32 v41, v41, v33
    v_max_f32 v42, v42, v34
    v_max_f32 v43, v43, v35
    v_add_f32 v40, v40, v44
    v_add_f32 v41, v41, v45
    v_add_f32 v42, v42, v46
    v_add_f32 v43, v43, v47
    v_cvt_pk_bf16_f32 v40, v40, v41
    v_cvt_pk_bf16_f32 v41, v42, v43
    buffer_store_dwordx2 v[40:41], v30, s[36:39], s45 offen
L_fin:
L_end:
    s_endpgm
L_evt_b0:
    s_and_b64 s[52:53], s[46:47], s[48:49]
    s_cbranch_scc0 L_ev2_b0
    s_mul_i32 exec_lo, s52, 0xffff
    s_mul_i32 exec_hi, s53, 0xffff
    ds_write_b128 v82, v[16:19] offset:64768
    ds_write_b128 v82, v[12:15] offset:65024
    ds_read_b128 v[8:11], v82
    ds_read_b128 v[16:19], v112
    ds_read_b128 v[12:15], v112
    v_add_u32 v82, 512, v82
    s_mov_b64 exec, -1
L_ev2_b0:
    s_lshr_b64 s[46:47], s[46:47], 1
    s_and_b64 s[46:47], s[46:47], s[48:49]
    s_cbranch_scc0 L_eback_b0
    s_mul_i32 exec_lo, s46, 0xffff
    s_mul_i32 exec_hi, s47, 0xffff
    v_add_u32 v81, 528, v81
    v_subrev_u32 v80, 16, v81
    s_mov_b64 exec, -1
    s_branch L_eback_b0
L_evt_b1:
    s_and_b64 s[52:53], s[46:47], s[48:49]
    s_cbranch_scc0 L_ev2_b1
    s_mul_i32 exec_lo, s52, 0xffff
    s_mul_i32 exec_hi, s53, 0xffff
    ds_write_b128 v82, v[16:19] offset:64768
    ds_write_b128 v82, v[12:15] offset:65024
    ds_read_b128 v[8:11], v82
    ds_read_b128 v[16:19], v112
    ds_read_b128 v[12:15], v112
    v_add_u32 v82, 512, v82
    s_mov_b64 exec, -1
L_ev2_b1:
    s_lshr_b64 s[46:47], s[46:47], 1
    s_and_b64 s[46:47], s[46:47], s[48:49]
    s_cbranch_scc0 L_eback_b1
    s_mul_i32 exec_lo, s46, 0xffff
    s_mul_i32 exec_hi, s47, 0xffff
    v_add_u32 v81, 528, v81
    v_subrev_u32 v80, 16, v81
    s_mov_b64 exec, -1
    s_branch L_eback_b1
L_evt_b2:
    s_and_b64 s[52:53], s[46:47], s[48:49]
    s_cbranch_scc0 L_ev2_b2
    s_mul_i32 exec_lo, s52, 0xffff
    s_mul_i32 exec_hi, s53, 0xffff
    ds_write_b128 v82, v[16:19] offset:64768
    ds_write_b128 v82, v[12:15] offset:65024
    ds_read_b128 v[8:11], v82
    ds_read_b128 v[16:19], v112
    ds_read_b128 v[12:15], v112
    v_add_u32 v82, 512, v82
    s_mov_b64 exec, -1
L_ev2_b2:
    s_lshr_b64 s[46:47], s[46:47], 1
    s_and_b64 s[46:47], s[46:47], s[48:49]
    s_cbranch_scc0 L_eback_b2
    s_mul_i32 exec_lo, s46, 0xffff
    s_mul_i32 exec_hi, s47, 0xffff
    v_add_u32 v81, 528, v81
    v_subrev_u32 v80, 16, v81
    s_mov_b64 exec, -1
    s_branch L_eback_b2
L_evt_z:
    s_and_b64 s[52:53], s[46:47], s[48:49]
    s_cbranch_scc0 L_ev2_z
    s_mul_i32 exec_lo, s52, 0xffff
    s_mul_i32 exec_hi, s53, 0xffff
    ds_write_b128 v82, v[16:19] offset:64768
    ds_write_b128 v82, v[12:15] offset:65024
    ds_read_b128 v[8:11], v82
    ds_read_b128 v[16:19], v112
    ds_read_b128 v[12:15], v112
    v_add_u32 v82, 512, v82
    s_mov_b64 exec, -1
L_ev2_z:
    s_branch L_eback_z
L_gowait:
    s_sleep 4
    global_load_dwordx2 v[50:51], v46, s[24:25] sc1
    s_add_u32 s43, s43, 1
    s_cmp_lt_u32 s43, 20000
    s_cbranch_scc1 L_gop
    v_mov_b32 v16, 1536
    v_mov_b32 v17, 32
    ds_or_b32 v16, v17
    ds_or_b32 v16, v17 offset:4
    ds_or_b32 v16, v17 offset:36
    s_waitcnt vmcnt(0)
    s_branch L_goback
L_repoll:
    s_mov_b64 exec, vcc
    s_add_u32 s43, s43, 1
    s_cmp_gt_u32 s43, 20000
    s_cbranch_scc1 L_timeout
    s_sleep 4
    global_load_dwordx2 v[94:95], v115, s[26:27] sc1
    s_branch L_poll
L_tpw:
    v_xor_b32 v94, 16, v94
    v_cmp_eq_u64 vcc, v[92:93], v[94:95]
    s_cbranch_vccnz L_timeout
    s_add_u32 s43, s43, 1
    s_cmp_gt_u32 s43, 20000
    s_cbranch_scc1 L_timeout
    s_sleep 4
    global_load_dwordx2 v[94:95], v113, s[26:27] sc1
    s_branch L_tp
L_ebad:
    v_mov_b32 v16, 1536
    v_mov_b32 v17, 16
    ds_or_b32 v16, v17
    s_branch L_ebad_back
L_timeout:
    s_mov_b64 exec, -1
    v_mov_b32 v10, 1540
    v_mov_b32 v11, 16
    ds_or_b32 v10, v11
    s_branch L_b4
L_wbad:
    v_mov_b32 v16, 1540
    v_mov_b32 v17, 16
    ds_or_b32 v16, v17
    s_branch L_wbad_back
L_rare:
    v_cmp_lt_u32 vcc, 0xffffff, v94
    s_cbranch_vccnz L_timeout
    v_lshl_add_u32 v8, v10, 2, v114
    v_lshl_add_u32 v8, v9, 4, v8
    v_add_u32 v8, 128, v8
    v_lshlrev_b32 v7, 2, v9
    v_sub_u32 v7, v2, v7
    v_subrev_u32 v7, 32, v7
L_rl:
    v_cmp_lt_i32 vcc, 0, v7
    s_cbranch_vccz L_rare_back
    s_mov_b64 exec, vcc
    global_load_dwordx4 v[88:91], v8, s[26:27] sc1
    s_mov_b64 exec, -1
    s_waitcnt vmcnt(0)
    v_cmp_lt_i32 s[44:45], 0, v7
    v_alignbit_b32 v74, v88, v88, 25
    v_and_b32 v74, 0x1bc, v74
    s_mov_b64 exec, s[44:45]
    ds_add_rtn_u32 v82, v74, v119 offset:1024
    s_mov_b64 exec, -1
    v_cmp_lt_i32 s[46:47], 1, v7
    v_alignbit_b32 v75, v89, v89, 25
    v_and_b32 v75, 0x1bc, v75
    s_mov_b64 exec, s[46:47]
    ds_add_rtn_u32 v83, v75, v119 offset:1024
    s_mov_b64 exec, -1
    v_cmp_lt_i32 s[48:49], 2, v7
    v_alignbit_b32 v76, v90, v90, 25
    v_and_b32 v76, 0x1bc, v76
    s_mov_b64 exec, s[48:49]
    ds_add_rtn_u32 v84, v76, v119 offset:1024
    s_mov_b64 exec, -1
    v_cmp_lt_i32 s[50:51], 3, v7
    v_alignbit_b32 v77, v91, v91, 25
    v_and_b32 v77, 0x1bc, v77
    s_mov_b64 exec, s[50:51]
    ds_add_rtn_u32 v85, v77, v119 offset:1024
    s_mov_b64 exec, -1
    v_and_b32 v74, 0x87ff0000, v88
    v_and_b32 v75, 0x87ff0000, v89
    v_and_b32 v76, 0x87ff0000, v90
    v_and_b32 v77, 0x87ff0000, v91
    v_fma_f32 v74, v74, s64, v126
    v_fma_f32 v75, v75, s64, v126
    v_fma_f32 v76, v76, s64, v126
    v_fma_f32 v77, v77, s64, v126
    v_and_b32 v74, 0x7ffe, v74
    v_and_b32 v75, 0x7ffe, v75
    v_and_b32 v76, 0x7ffe, v76
    v_and_b32 v77, 0x7ffe, v77
    v_lshrrev_b32_sdwa v74, s65, v88 dst_sel:WORD_1 dst_unused:UNUSED_PRESERVE src0_sel:DWORD src1_sel:WORD_0
    v_lshrrev_b32_sdwa v75, s65, v89 dst_sel:WORD_1 dst_unused:UNUSED_PRESERVE src0_sel:DWORD src1_sel:WORD_0
    v_lshrrev_b32_sdwa v76, s65, v90 dst_sel:WORD_1 dst_unused:UNUSED_PRESERVE src0_sel:DWORD src1_sel:WORD_0
    v_lshrrev_b32_sdwa v77, s65, v91 dst_sel:WORD_1 dst_unused:UNUSED_PRESERVE src0_sel:DWORD src1_sel:WORD_0
    s_waitcnt lgkmcnt(0)
    s_mov_b64 exec, s[44:45]
    ds_write_b32 v82, v74
    s_mov_b64 exec, s[46:47]
    ds_write_b32 v83, v75
    s_mov_b64 exec, s[48:49]
    ds_write_b32 v84, v76
    s_mov_b64 exec, s[50:51]
    ds_write_b32 v85, v77
    s_mov_b64 exec, -1
    v_add_u32 v8, 64, v8
    v_subrev_u32 v7, 16, v7
    s_branch L_rl
L_slow:
    s_setprio 0
    s_waitcnt lgkmcnt(0)
    s_barrier
    v_lshlrev_b32 v8, 4, v0
    v_lshlrev_b32 v10, 3, v0
    v_lshlrev_b32 v11, 1, v116
    v_lshlrev_b32 v5, 2, v116
    v_mov_b32 v9, v116
    v_mov_b32 v60, 1.0
    v_mov_b32 v61, 1.0
    v_mov_b32 v62, 1.0
    v_mov_b32 v63, 1.0
    v_add_u32 v7, 134912, v8
    s_mov_b32 s42, 0x05040100
    s_mov_b32 s43, 0x07060302
    global_load_dwordx2 v[20:21], v10, s[14:15]
    global_load_dwordx2 v[22:23], v10, s[20:21]
    global_load_ushort v4, v11, s[16:17]
    v_lshrrev_b32 v28, 4, v0
    v_lshl_add_u32 v28, v28, 9, v1
    ds_write_b128 v28, v[60:63] offset:44032
    s_cmp_lt_u32 s3, 12
    s_cbranch_scc1 L_s_noa
    v_add_u32 v120, 11008, v120
    ds_write2_b32 v120, v96, v100 offset0:0 offset1:1
    ds_write2_b32 v120, v104, v108 offset0:2 offset1:3
    ds_write2_b32 v120, v97, v101 offset0:64 offset1:65
    ds_write2_b32 v120, v105, v109 offset0:66 offset1:67
    ds_write2_b32 v120, v98, v102 offset0:128 offset1:129
    ds_write2_b32 v120, v106, v110 offset0:130 offset1:131
    ds_write2_b32 v120, v99, v103 offset0:192 offset1:193
    ds_write2_b32 v120, v107, v111 offset0:194 offset1:195
L_s_noa:
    s_waitcnt vmcnt(0)
    v_perm_b32 v24, v22, v20, s42
    v_perm_b32 v25, v22, v20, s43
    v_perm_b32 v26, v23, v21, s42
    v_perm_b32 v27, v23, v21, s43
    ds_write_b128 v7, v[24:27]
    v_lshlrev_b32 v4, 16, v4
    v_add_u32 v6, 134912, v5
    s_waitcnt lgkmcnt(0)
    s_barrier
    ds_read_b32 v64, v6 offset:0
    ds_read_b32 v65, v6 offset:256
    ds_read_b32 v66, v6 offset:512
    ds_read_b32 v67, v6 offset:768
    ds_read_b32 v68, v6 offset:1024
    ds_read_b32 v69, v6 offset:1280
    ds_read_b32 v70, v6 offset:1536
    ds_read_b32 v71, v6 offset:1792
    ds_read_b32 v72, v6 offset:2048
    ds_read_b32 v73, v6 offset:2304
    ds_read_b32 v74, v6 offset:2560
    ds_read_b32 v75, v6 offset:2816
    ds_read_b32 v76, v6 offset:3072
    ds_read_b32 v77, v6 offset:3328
    ds_read_b32 v78, v6 offset:3584
    ds_read_b32 v79, v6 offset:3840
    ds_read_b32 v80, v6 offset:4096
    ds_read_b32 v81, v6 offset:4352
    ds_read_b32 v82, v6 offset:4608
    ds_read_b32 v83, v6 offset:4864
    ds_read_b32 v84, v6 offset:5120
    ds_read_b32 v85, v6 offset:5376
    ds_read_b32 v86, v6 offset:5632
    ds_read_b32 v87, v6 offset:5888
    ds_read_b32 v88, v6 offset:6144
    ds_read_b32 v89, v6 offset:6400
    ds_read_b32 v90, v6 offset:6656
    ds_read_b32 v91, v6 offset:6912
    ds_read_b32 v92, v6 offset:7168
    ds_read_b32 v93, v6 offset:7424
    ds_read_b32 v94, v6 offset:7680
    ds_read_b32 v95, v6 offset:7936
    ds_read_b32 v96, v6 offset:8192
    ds_read_b32 v97, v6 offset:8448
    ds_read_b32 v98, v6 offset:8704
    ds_read_b32 v99, v6 offset:8960
    ds_read_b32 v100, v6 offset:9216
    ds_read_b32 v101, v6 offset:9472
    ds_read_b32 v102, v6 offset:9728
    ds_read_b32 v103, v6 offset:9984
    ds_read_b32 v104, v6 offset:10240
    ds_read_b32 v105, v6 offset:10496
    ds_read_b32 v106, v6 offset:10752
    ds_read_b32 v107, v6 offset:11008
    ds_read_b32 v108, v6 offset:11264
    ds_read_b32 v109, v6 offset:11520
    ds_read_b32 v110, v6 offset:11776
    ds_read_b32 v111, v6 offset:12032
    ds_read_b32 v112, v6 offset:12288
    ds_read_b32 v113, v6 offset:12544
    ds_read_b32 v114, v6 offset:12800
    ds_read_b32 v115, v6 offset:13056
    ds_read_b32 v116, v6 offset:13312
    ds_read_b32 v117, v6 offset:13568
    ds_read_b32 v118, v6 offset:13824
    ds_read_b32 v119, v6 offset:14080
    ds_read_b32 v120, v6 offset:14336
    ds_read_b32 v121, v6 offset:14592
    ds_read_b32 v122, v6 offset:14848
    ds_read_b32 v123, v6 offset:15104
    ds_read_b32 v124, v6 offset:15360
    ds_read_b32 v125, v6 offset:15616
    ds_read_b32 v126, v6 offset:15872
    ds_read_b32 v127, v6 offset:16128
    s_mul_i32 s44, s3, 50000
    s_add_u32 s45, s44, 50000
    s_mov_b32 s53, 0xbfb8aa3b
    s_mov_b32 s54, 0x42800000
    s_waitcnt lgkmcnt(0)
L_s_scan:
    v_add_u32 v30, s44, v9
    v_cmp_gt_u32 s[46:47], s45, v30
    v_min_u32 v30, 799999, v30
    v_lshlrev_b32 v31, 2, v30
    v_lshlrev_b32 v30, 1, v30
    global_load_dword v32, v31, s[10:11]
    global_load_dword v33, v31, s[8:9]
    global_load_ushort v34, v30, s[6:7]
    s_waitcnt vmcnt(0)
    v_subrev_u32 v32, s60, v32
    v_cmp_gt_u32 vcc, 49, v32
    v_min_u32 v33, 12499, v33
    v_lshlrev_b32 v34, 16, v34
    s_and_b64 s[46:47], s[46:47], vcc
L_s_edge:
    s_cmp_eq_u64 s[46:47], 0
    s_cbranch_scc1 L_s_next
    s_ff1_i32_b64 s48, s[46:47]
    s_bitset0_b64 s[46:47], s48
    v_readlane_b32 s49, v32, s48
    v_readlane_b32 s50, v33, s48
    v_readlane_b32 s51, v34, s48
    s_nop 1
    s_lshl_b32 s50, s50, 7
    v_add_u32 v20, s50, v11
    global_load_ushort v21, v20, s[4:5]
    s_lshl_b32 s50, s49, 8
    s_add_u32 s50, s50, 11008
    v_add_u32 v22, s50, v5
    ds_read_b32 v23, v22
    s_lshl_b32 s50, s49, 9
    s_add_u32 s50, s50, 109312
    v_add_u32 v22, s50, v5
    v_mov_b32 v24, 0
    v_mov_b32 v25, 0
    s_waitcnt vmcnt(0) lgkmcnt(0)
    v_lshlrev_b32 v21, 16, v21
    v_fmac_f32 v23, s51, v4
    v_readlane_b32 s52, v21, 0
    v_lshlrev_b32 v26, 16, v64
    v_and_b32 v27, 0xffff0000, v64
    v_fmac_f32 v24, s52, v26
    v_fmac_f32 v25, s52, v27
    v_readlane_b32 s52, v21, 1
    v_lshlrev_b32 v26, 16, v65
    v_and_b32 v27, 0xffff0000, v65
    v_fmac_f32 v24, s52, v26
    v_fmac_f32 v25, s52, v27
    v_readlane_b32 s52, v21, 2
    v_lshlrev_b32 v26, 16, v66
    v_and_b32 v27, 0xffff0000, v66
    v_fmac_f32 v24, s52, v26
    v_fmac_f32 v25, s52, v27
    v_readlane_b32 s52, v21, 3
    v_lshlrev_b32 v26, 16, v67
    v_and_b32 v27, 0xffff0000, v67
    v_fmac_f32 v24, s52, v26
    v_fmac_f32 v25, s52, v27
    v_readlane_b32 s52, v21, 4
    v_lshlrev_b32 v26, 16, v68
    v_and_b32 v27, 0xffff0000, v68
    v_fmac_f32 v24, s52, v26
    v_fmac_f32 v25, s52, v27
    v_readlane_b32 s52, v21, 5
    v_lshlrev_b32 v26, 16, v69
    v_and_b32 v27, 0xffff0000, v69
    v_fmac_f32 v24, s52, v26
    v_fmac_f32 v25, s52, v27
    v_readlane_b32 s52, v21, 6
    v_lshlrev_b32 v26, 16, v70
    v_and_b32 v27, 0xffff0000, v70
    v_fmac_f32 v24, s52, v26
    v_fmac_f32 v25, s52, v27
    v_readlane_b32 s52, v21, 7
    v_lshlrev_b32 v26, 16, v71
    v_and_b32 v27, 0xffff0000, v71
    v_fmac_f32 v24, s52, v26
    v_fmac_f32 v25, s52, v27
    v_readlane_b32 s52, v21, 8
    v_lshlrev_b32 v26, 16, v72
    v_and_b32 v27, 0xffff0000, v72
    v_fmac_f32 v24, s52, v26
    v_fmac_f32 v25, s52, v27
    v_readlane_b32 s52, v21, 9
    v_lshlrev_b32 v26, 16, v73
    v_and_b32 v27, 0xffff0000, v73
    v_fmac_f32 v24, s52, v26
    v_fmac_f32 v25, s52, v27
    v_readlane_b32 s52, v21, 10
    v_lshlrev_b32 v26, 16, v74
    v_and_b32 v27, 0xffff0000, v74
    v_fmac_f32 v24, s52, v26
    v_fmac_f32 v25, s52, v27
    v_readlane_b32 s52, v21, 11
    v_lshlrev_b32 v26, 16, v75
    v_and_b32 v27, 0xffff0000, v75
    v_fmac_f32 v24, s52, v26
    v_fmac_f32 v25, s52, v27
    v_readlane_b32 s52, v21, 12
    v_lshlrev_b32 v26, 16, v76
    v_and_b32 v27, 0xffff0000, v76
    v_fmac_f32 v24, s52, v26
    v_fmac_f32 v25, s52, v27
    v_readlane_b32 s52, v21, 13
    v_lshlrev_b32 v26, 16, v77
    v_and_b32 v27, 0xffff0000, v77
    v_fmac_f32 v24, s52, v26
    v_fmac_f32 v25, s52, v27
    v_readlane_b32 s52, v21, 14
    v_lshlrev_b32 v26, 16, v78
    v_and_b32 v27, 0xffff0000, v78
    v_fmac_f32 v24, s52, v26
    v_fmac_f32 v25, s52, v27
    v_readlane_b32 s52, v21, 15
    v_lshlrev_b32 v26, 16, v79
    v_and_b32 v27, 0xffff0000, v79
    v_fmac_f32 v24, s52, v26
    v_fmac_f32 v25, s52, v27
    v_readlane_b32 s52, v21, 16
    v_lshlrev_b32 v26, 16, v80
    v_and_b32 v27, 0xffff0000, v80
    v_fmac_f32 v24, s52, v26
    v_fmac_f32 v25, s52, v27
    v_readlane_b32 s52, v21, 17
    v_lshlrev_b32 v26, 16, v81
    v_and_b32 v27, 0xffff0000, v81
    v_fmac_f32 v24, s52, v26
    v_fmac_f32 v25, s52, v27
    v_readlane_b32 s52, v21, 18
    v_lshlrev_b32 v26, 16, v82
    v_and_b32 v27, 0xffff0000, v82
    v_fmac_f32 v24, s52, v26
    v_fmac_f32 v25, s52, v27
    v_readlane_b32 s52, v21, 19
    v_lshlrev_b32 v26, 16, v83
    v_and_b32 v27, 0xffff0000, v83
    v_fmac_f32 v24, s52, v26
    v_fmac_f32 v25, s52, v27
    v_readlane_b32 s52, v21, 20
    v_lshlrev_b32 v26, 16, v84
    v_and_b32 v27, 0xffff0000, v84
    v_fmac_f32 v24, s52, v26
    v_fmac_f32 v25, s52, v27
    v_readlane_b32 s52, v21, 21
    v_lshlrev_b32 v26, 16, v85
    v_and_b32 v27, 0xffff0000, v85
    v_fmac_f32 v24, s52, v26
    v_fmac_f32 v25, s52, v27
    v_readlane_b32 s52, v21, 22
    v_lshlrev_b32 v26, 16, v86
    v_and_b32 v27, 0xffff0000, v86
    v_fmac_f32 v24, s52, v26
    v_fmac_f32 v25, s52, v27
    v_readlane_b32 s52, v21, 23
    v_lshlrev_b32 v26, 16, v87
    v_and_b32 v27, 0xffff0000, v87
    v_fmac_f32 v24, s52, v26
    v_fmac_f32 v25, s52, v27
    v_readlane_b32 s52, v21, 24
    v_lshlrev_b32 v26, 16, v88
    v_and_b32 v27, 0xffff0000, v88
    v_fmac_f32 v24, s52, v26
    v_fmac_f32 v25, s52, v27
    v_readlane_b32 s52, v21, 25
    v_lshlrev_b32 v26, 16, v89
    v_and_b32 v27, 0xffff0000, v89
    v_fmac_f32 v24, s52, v26
    v_fmac_f32 v25, s52, v27
    v_readlane_b32 s52, v21, 26
    v_lshlrev_b32 v26, 16, v90
    v_and_b32 v27, 0xffff0000, v90
    v_fmac_f32 v24, s52, v26
    v_fmac_f32 v25, s52, v27
    v_readlane_b32 s52, v21, 27
    v_lshlrev_b32 v26, 16, v91
    v_and_b32 v27, 0xffff0000, v91
    v_fmac_f32 v24, s52, v26
    v_fmac_f32 v25, s52, v27
    v_readlane_b32 s52, v21, 28
    v_lshlrev_b32 v26, 16, v92
    v_and_b32 v27, 0xffff0000, v92
    v_fmac_f32 v24, s52, v26
    v_fmac_f32 v25, s52, v27
    v_readlane_b32 s52, v21, 29
    v_lshlrev_b32 v26, 16, v93
    v_and_b32 v27, 0xffff0000, v93
    v_fmac_f32 v24, s52, v26
    v_fmac_f32 v25, s52, v27
    v_readlane_b32 s52, v21, 30
    v_lshlrev_b32 v26, 16, v94
    v_and_b32 v27, 0xffff0000, v94
    v_fmac_f32 v24, s52, v26
    v_fmac_f32 v25, s52, v27
    v_readlane_b32 s52, v21, 31
    v_lshlrev_b32 v26, 16, v95
    v_and_b32 v27, 0xffff0000, v95
    v_fmac_f32 v24, s52, v26
    v_fmac_f32 v25, s52, v27
    v_readlane_b32 s52, v21, 32
    v_lshlrev_b32 v26, 16, v96
    v_and_b32 v27, 0xffff0000, v96
    v_fmac_f32 v24, s52, v26
    v_fmac_f32 v25, s52, v27
    v_readlane_b32 s52, v21, 33
    v_lshlrev_b32 v26, 16, v97
    v_and_b32 v27, 0xffff0000, v97
    v_fmac_f32 v24, s52, v26
    v_fmac_f32 v25, s52, v27
    v_readlane_b32 s52, v21, 34
    v_lshlrev_b32 v26, 16, v98
    v_and_b32 v27, 0xffff0000, v98
    v_fmac_f32 v24, s52, v26
    v_fmac_f32 v25, s52, v27
    v_readlane_b32 s52, v21, 35
    v_lshlrev_b32 v26, 16, v99
    v_and_b32 v27, 0xffff0000, v99
    v_fmac_f32 v24, s52, v26
    v_fmac_f32 v25, s52, v27
    v_readlane_b32 s52, v21, 36
    v_lshlrev_b32 v26, 16, v100
    v_and_b32 v27, 0xffff0000, v100
    v_fmac_f32 v24, s52, v26
    v_fmac_f32 v25, s52, v27
    v_readlane_b32 s52, v21, 37
    v_lshlrev_b32 v26, 16, v101
    v_and_b32 v27, 0xffff0000, v101
    v_fmac_f32 v24, s52, v26
    v_fmac_f32 v25, s52, v27
    v_readlane_b32 s52, v21, 38
    v_lshlrev_b32 v26, 16, v102
    v_and_b32 v27, 0xffff0000, v102
    v_fmac_f32 v24, s52, v26
    v_fmac_f32 v25, s52, v27
    v_readlane_b32 s52, v21, 39
    v_lshlrev_b32 v26, 16, v103
    v_and_b32 v27, 0xffff0000, v103
    v_fmac_f32 v24, s52, v26
    v_fmac_f32 v25, s52, v27
    v_readlane_b32 s52, v21, 40
    v_lshlrev_b32 v26, 16, v104
    v_and_b32 v27, 0xffff0000, v104
    v_fmac_f32 v24, s52, v26
    v_fmac_f32 v25, s52, v27
    v_readlane_b32 s52, v21, 41
    v_lshlrev_b32 v26, 16, v105
    v_and_b32 v27, 0xffff0000, v105
    v_fmac_f32 v24, s52, v26
    v_fmac_f32 v25, s52, v27
    v_readlane_b32 s52, v21, 42
    v_lshlrev_b32 v26, 16, v106
    v_and_b32 v27, 0xffff0000, v106
    v_fmac_f32 v24, s52, v26
    v_fmac_f32 v25, s52, v27
    v_readlane_b32 s52, v21, 43
    v_lshlrev_b32 v26, 16, v107
    v_and_b32 v27, 0xffff0000, v107
    v_fmac_f32 v24, s52, v26
    v_fmac_f32 v25, s52, v27
    v_readlane_b32 s52, v21, 44
    v_lshlrev_b32 v26, 16, v108
    v_and_b32 v27, 0xffff0000, v108
    v_fmac_f32 v24, s52, v26
    v_fmac_f32 v25, s52, v27
    v_readlane_b32 s52, v21, 45
    v_lshlrev_b32 v26, 16, v109
    v_and_b32 v27, 0xffff0000, v109
    v_fmac_f32 v24, s52, v26
    v_fmac_f32 v25, s52, v27
    v_readlane_b32 s52, v21, 46
    v_lshlrev_b32 v26, 16, v110
    v_and_b32 v27, 0xffff0000, v110
    v_fmac_f32 v24, s52, v26
    v_fmac_f32 v25, s52, v27
    v_readlane_b32 s52, v21, 47
    v_lshlrev_b32 v26, 16, v111
    v_and_b32 v27, 0xffff0000, v111
    v_fmac_f32 v24, s52, v26
    v_fmac_f32 v25, s52, v27
    v_readlane_b32 s52, v21, 48
    v_lshlrev_b32 v26, 16, v112
    v_and_b32 v27, 0xffff0000, v112
    v_fmac_f32 v24, s52, v26
    v_fmac_f32 v25, s52, v27
    v_readlane_b32 s52, v21, 49
    v_lshlrev_b32 v26, 16, v113
    v_and_b32 v27, 0xffff0000, v113
    v_fmac_f32 v24, s52, v26
    v_fmac_f32 v25, s52, v27
    v_readlane_b32 s52, v21, 50
    v_lshlrev_b32 v26, 16, v114
    v_and_b32 v27, 0xffff0000, v114
    v_fmac_f32 v24, s52, v26
    v_fmac_f32 v25, s52, v27
    v_readlane_b32 s52, v21, 51
    v_lshlrev_b32 v26, 16, v115
    v_and_b32 v27, 0xffff0000, v115
    v_fmac_f32 v24, s52, v26
    v_fmac_f32 v25, s52, v27
    v_readlane_b32 s52, v21, 52
    v_lshlrev_b32 v26, 16, v116
    v_and_b32 v27, 0xffff0000, v116
    v_fmac_f32 v24, s52, v26
    v_fmac_f32 v25, s52, v27
    v_readlane_b32 s52, v21, 53
    v_lshlrev_b32 v26, 16, v117
    v_and_b32 v27, 0xffff0000, v117
    v_fmac_f32 v24, s52, v26
    v_fmac_f32 v25, s52, v27
    v_readlane_b32 s52, v21, 54
    v_lshlrev_b32 v26, 16, v118
    v_and_b32 v27, 0xffff0000, v118
    v_fmac_f32 v24, s52, v26
    v_fmac_f32 v25, s52, v27
    v_readlane_b32 s52, v21, 55
    v_lshlrev_b32 v26, 16, v119
    v_and_b32 v27, 0xffff0000, v119
    v_fmac_f32 v24, s52, v26
    v_fmac_f32 v25, s52, v27
    v_readlane_b32 s52, v21, 56
    v_lshlrev_b32 v26, 16, v120
    v_and_b32 v27, 0xffff0000, v120
    v_fmac_f32 v24, s52, v26
    v_fmac_f32 v25, s52, v27
    v_readlane_b32 s52, v21, 57
    v_lshlrev_b32 v26, 16, v121
    v_and_b32 v27, 0xffff0000, v121
    v_fmac_f32 v24, s52, v26
    v_fmac_f32 v25, s52, v27
    v_readlane_b32 s52, v21, 58
    v_lshlrev_b32 v26, 16, v122
    v_and_b32 v27, 0xffff0000, v122
    v_fmac_f32 v24, s52, v26
    v_fmac_f32 v25, s52, v27
    v_readlane_b32 s52, v21, 59
    v_lshlrev_b32 v26, 16, v123
    v_and_b32 v27, 0xffff0000, v123
    v_fmac_f32 v24, s52, v26
    v_fmac_f32 v25, s52, v27
    v_readlane_b32 s52, v21, 60
    v_lshlrev_b32 v26, 16, v124
    v_and_b32 v27, 0xffff0000, v124
    v_fmac_f32 v24, s52, v26
    v_fmac_f32 v25, s52, v27
    v_readlane_b32 s52, v21, 61
    v_lshlrev_b32 v26, 16, v125
    v_and_b32 v27, 0xffff0000, v125
    v_fmac_f32 v24, s52, v26
    v_fmac_f32 v25, s52, v27
    v_readlane_b32 s52, v21, 62
    v_lshlrev_b32 v26, 16, v126
    v_and_b32 v27, 0xffff0000, v126
    v_fmac_f32 v24, s52, v26
    v_fmac_f32 v25, s52, v27
    v_readlane_b32 s52, v21, 63
    v_lshlrev_b32 v26, 16, v127
    v_and_b32 v27, 0xffff0000, v127
    v_fmac_f32 v24, s52, v26
    v_fmac_f32 v25, s52, v27
    v_add_f32 v23, v23, v24
    v_mul_f32 v23, s53, v23
    v_exp_f32 v23, v23
    v_mul_f32 v25, s54, v25
    v_add_f32 v23, 1.0, v23
    v_rcp_f32 v23, v23
    s_nop 0
    v_mul_f32 v25, v25, v23
    ds_add_f32 v22, v25
    ds_add_f32 v22, v23 offset:256
    s_branch L_s_edge
L_s_next:
    s_add_u32 s44, s44, 64
    s_cmp_lt_u32 s44, s45
    s_cbranch_scc1 L_s_scan
    s_branch L_epi
.section .rodata,"a"
.p2align 6
.amdhsa_kernel standalone__edge_featured_mpnn_gatedgcn__graph_kernel
  .amdhsa_next_free_vgpr 128
  .amdhsa_next_free_sgpr 100
  .amdhsa_accum_offset 128
  .amdhsa_group_segment_fixed_size 0
  .amdhsa_kernarg_size 96
  .amdhsa_user_sgpr_count 2
  .amdhsa_user_sgpr_kernarg_segment_ptr 1
  .amdhsa_system_sgpr_workgroup_id_x 1
  .amdhsa_float_denorm_mode_32 3
.end_amdhsa_kernel
```
